```python
import torch

def _softmax(x, axis=-1):
    return torch.softmax(x, dim=axis)
def _gelu(x):
    return torch.nn.functional.gelu(x, approximate="tanh")
def _silu(x):
    return torch.nn.functional.silu(x)
def _sigmoid(x):
    return torch.sigmoid(x)
def _layernorm(x, axis=-1, eps=1e-5):
    m = x.mean(dim=axis, keepdim=True)
    v = x.var(dim=axis, keepdim=True, unbiased=False)
    return (x - m) / torch.sqrt(v + eps)
def _scatter_add(tgt, idx, src, axis=0):
    return tgt.clone().index_add_(axis, idx, src)
def _segment_sum(src, seg, n):
    out = torch.zeros((n,) + src.shape[1:], dtype=src.dtype)
    return out.index_add_(0, seg, src)
def _pad(x, pw):
    flat = tuple(v for pair in reversed(pw) for v in pair)
    return torch.nn.functional.pad(x, flat)

kernel_name = 'standalone__block_sparse_attn__prompt'

def setup_inputs():

    _w = (lambda a: (lambda t: t.to(torch.bfloat16) if t.is_floating_point() else t)(torch.as_tensor(a)))
    B, H, S, D = 1, 16, 2048, 256
    bs = 64; nb = S // bs
    bm = (torch.rand(nb, nb) < 0.15).to(float)
    bm = torch.maximum(bm, torch.eye(nb, dtype=float))
    return {
        "q": _w((lambda *s: torch.randn(*s, dtype=torch.bfloat16) * 0.8)(B, H, S, D)),
        "k": _w((lambda *s: torch.randn(*s, dtype=torch.bfloat16) * 0.8)(B, H, S, D)),
        "v": _w((lambda *s: torch.randn(*s, dtype=torch.bfloat16) * 0.05)(B, H, S, D)),
        "block_mask": _w(bm),
    }

def reference(q, k, v, block_mask):
    B, H, S, D = q.shape
    bs = 64
    mask = torch.kron(block_mask, torch.ones((bs, bs), dtype=q.dtype))[:S, :S]
    scores = torch.einsum("bhqd,bhkd->bhqk", q, k) * (D ** -0.5)
    scores = torch.where(mask[None, None] > 0, scores, -1e9)
    p = _softmax(scores, axis=-1)
    return torch.einsum("bhqk,bhkd->bhqd", p, v)
```

```asm
; @launch grid=(256,1,1) block=(512,1,1) lds=141568
.amdgcn_target "amdgcn-amd-amdhsa--gfx950"
.text
.globl standalone__block_sparse_attn__prompt_kernel
.p2align 8
.type standalone__block_sparse_attn__prompt_kernel,@function
standalone__block_sparse_attn__prompt_kernel:
    s_cmp_ge_u32 s2, 256
    s_cbranch_scc1 L_end
    s_load_dwordx8 s[68:75], s[0:1], 0
    s_load_dwordx2 s[76:77], s[0:1], 32
    v_lshrrev_b32 v1, 6, v0
    v_and_b32 v8, 63, v0
    v_readfirstlane_b32 s24, v1
    v_mov_b32 v0, 0
    s_lshr_b32 s25, s2, 3
    s_and_b32 s26, s2, 7
    s_lshl_b32 s26, s26, 20
    s_add_u32 s31, s26, 0x800000
    s_lshl_b32 s37, s25, 15
    s_add_u32 s37, s37, s26
    v_and_b32 v2, 31, v8
    v_lshrrev_b32 v3, 5, v8
    v_lshlrev_b32 v4, 6, v2
    v_lshl_add_u32 v4, v3, 5, v4
    s_waitcnt lgkmcnt(0)
    s_mov_b32 s20, s74
    s_and_b32 s21, s75, 0xffff
    s_mov_b32 s22, 2048
    s_mov_b32 s23, 0x20000
    v_lshlrev_b32 v9, 1, v2
    s_lshl_b32 s51, s25, 6
    buffer_load_ushort v9, v9, s[20:23], s51 offen
    buffer_load_dwordx4 v[16:19], v4, s[20:23], 0 offen
    buffer_load_dwordx4 v[20:23], v4, s[20:23], 0 offen offset:16
    s_mov_b32 s4, s68
    s_and_b32 s5, s69, 0xffff
    s_mov_b32 s6, 16777216
    s_mov_b32 s7, 0x20000
    s_mov_b32 s8, s70
    s_and_b32 s9, s71, 0xffff
    s_mov_b32 s10, 16777216
    s_mov_b32 s11, 0x20000
    s_mov_b32 s12, s72
    s_and_b32 s13, s73, 0xffff
    s_mov_b32 s14, 16777216
    s_mov_b32 s15, 0x20000
    s_mov_b32 s16, s76
    s_and_b32 s17, s77, 0xffff
    s_mov_b32 s18, 16777216
    s_mov_b32 s19, 0x20000
    s_cmp_lt_u32 s24, 4
    s_cbranch_scc1 L_nodma
    s_sub_u32 s51, s24, 4
    s_lshl_b32 s52, s51, 13
    v_lshl_add_u32 v1, v8, 4, s52
    s_mul_i32 s44, s51, 8320
    s_mul_i32 s45, s51, 8448
    s_add_u32 s45, s45, 66560
    s_add_u32 s53, s44, 33280
    s_add_u32 s54, s45, 33792
    s_add_u32 s51, s44, 66560
    s_add_u32 s52, s37, 4096
    s_add_u32 m0, s51, 0
    s_nop 0
    buffer_load_dwordx4 v1, s[4:7], s37 offen offset:0 lds
    s_add_u32 m0, s51, 16
    s_nop 0
    buffer_load_dwordx4 v1, s[4:7], s37 offen offset:1024 lds
    s_add_u32 m0, s51, 32
    s_nop 0
    buffer_load_dwordx4 v1, s[4:7], s37 offen offset:2048 lds
    s_add_u32 m0, s51, 48
    s_nop 0
    buffer_load_dwordx4 v1, s[4:7], s37 offen offset:3072 lds
    s_add_u32 m0, s51, 4160
    s_nop 0
    buffer_load_dwordx4 v1, s[4:7], s52 offen offset:0 lds
    s_add_u32 m0, s51, 4176
    s_nop 0
    buffer_load_dwordx4 v1, s[4:7], s52 offen offset:1024 lds
    s_add_u32 m0, s51, 4192
    s_nop 0
    buffer_load_dwordx4 v1, s[4:7], s52 offen offset:2048 lds
    s_add_u32 m0, s51, 4208
    s_nop 0
    buffer_load_dwordx4 v1, s[4:7], s52 offen offset:3072 lds
    s_waitcnt vmcnt(10)
    v_lshl_add_u32 v9, v9, 16, -1
    v_cmp_gt_u32 vcc, 0x7f800000, v9
    s_nop 1
    s_ff1_i32_b32 s51, vcc_lo
    s_max_i32 s51, s51, 0
    s_lshl_b32 s51, s51, 15
    s_add_u32 s37, s51, s26
    s_add_u32 s52, s37, 4096
    s_add_u32 m0, s53, 0
    s_nop 0
    buffer_load_dwordx4 v1, s[8:11], s37 offen offset:0 lds
    s_add_u32 m0, s53, 16
    s_nop 0
    buffer_load_dwordx4 v1, s[8:11], s37 offen offset:1024 lds
    s_add_u32 m0, s53, 32
    s_nop 0
    buffer_load_dwordx4 v1, s[8:11], s37 offen offset:2048 lds
    s_add_u32 m0, s53, 48
    s_nop 0
    buffer_load_dwordx4 v1, s[8:11], s37 offen offset:3072 lds
    s_add_u32 m0, s53, 4160
    s_nop 0
    buffer_load_dwordx4 v1, s[8:11], s52 offen offset:0 lds
    s_add_u32 m0, s53, 4176
    s_nop 0
    buffer_load_dwordx4 v1, s[8:11], s52 offen offset:1024 lds
    s_add_u32 m0, s53, 4192
    s_nop 0
    buffer_load_dwordx4 v1, s[8:11], s52 offen offset:2048 lds
    s_add_u32 m0, s53, 4208
    s_nop 0
    buffer_load_dwordx4 v1, s[8:11], s52 offen offset:3072 lds
    s_waitcnt vmcnt(16)
    s_branch L_mask
L_nodma:
    s_waitcnt vmcnt(0)
L_mask:
    v_mov_b32 v5, 0
    s_mov_b32 s52, 0x7f800000
    v_and_b32 v6, 0xffff0000, v23
    v_add_u32 v6, -1, v6
    v_cmp_gt_u32 vcc, s52, v6
    s_nop 1
    v_addc_co_u32 v5, vcc, v5, v5, vcc
    v_lshlrev_b32 v6, 16, v23
    v_add_u32 v6, -1, v6
    v_cmp_gt_u32 vcc, s52, v6
    s_nop 1
    v_addc_co_u32 v5, vcc, v5, v5, vcc
    v_and_b32 v6, 0xffff0000, v22
    v_add_u32 v6, -1, v6
    v_cmp_gt_u32 vcc, s52, v6
    s_nop 1
    v_addc_co_u32 v5, vcc, v5, v5, vcc
    v_lshlrev_b32 v6, 16, v22
    v_add_u32 v6, -1, v6
    v_cmp_gt_u32 vcc, s52, v6
    s_nop 1
    v_addc_co_u32 v5, vcc, v5, v5, vcc
    v_and_b32 v6, 0xffff0000, v21
    v_add_u32 v6, -1, v6
    v_cmp_gt_u32 vcc, s52, v6
    s_nop 1
    v_addc_co_u32 v5, vcc, v5, v5, vcc
    v_lshlrev_b32 v6, 16, v21
    v_add_u32 v6, -1, v6
    v_cmp_gt_u32 vcc, s52, v6
    s_nop 1
    v_addc_co_u32 v5, vcc, v5, v5, vcc
    v_and_b32 v6, 0xffff0000, v20
    v_add_u32 v6, -1, v6
    v_cmp_gt_u32 vcc, s52, v6
    s_nop 1
    v_addc_co_u32 v5, vcc, v5, v5, vcc
    v_lshlrev_b32 v6, 16, v20
    v_add_u32 v6, -1, v6
    v_cmp_gt_u32 vcc, s52, v6
    s_nop 1
    v_addc_co_u32 v5, vcc, v5, v5, vcc
    v_and_b32 v6, 0xffff0000, v19
    v_add_u32 v6, -1, v6
    v_cmp_gt_u32 vcc, s52, v6
    s_nop 1
    v_addc_co_u32 v5, vcc, v5, v5, vcc
    v_lshlrev_b32 v6, 16, v19
    v_add_u32 v6, -1, v6
    v_cmp_gt_u32 vcc, s52, v6
    s_nop 1
    v_addc_co_u32 v5, vcc, v5, v5, vcc
    v_and_b32 v6, 0xffff0000, v18
    v_add_u32 v6, -1, v6
    v_cmp_gt_u32 vcc, s52, v6
    s_nop 1
    v_addc_co_u32 v5, vcc, v5, v5, vcc
    v_lshlrev_b32 v6, 16, v18
    v_add_u32 v6, -1, v6
    v_cmp_gt_u32 vcc, s52, v6
    s_nop 1
    v_addc_co_u32 v5, vcc, v5, v5, vcc
    v_and_b32 v6, 0xffff0000, v17
    v_add_u32 v6, -1, v6
    v_cmp_gt_u32 vcc, s52, v6
    s_nop 1
    v_addc_co_u32 v5, vcc, v5, v5, vcc
    v_lshlrev_b32 v6, 16, v17
    v_add_u32 v6, -1, v6
    v_cmp_gt_u32 vcc, s52, v6
    s_nop 1
    v_addc_co_u32 v5, vcc, v5, v5, vcc
    v_and_b32 v6, 0xffff0000, v16
    v_add_u32 v6, -1, v6
    v_cmp_gt_u32 vcc, s52, v6
    s_nop 1
    v_addc_co_u32 v5, vcc, v5, v5, vcc
    v_lshlrev_b32 v6, 16, v16
    v_add_u32 v6, -1, v6
    v_cmp_gt_u32 vcc, s52, v6
    s_nop 1
    v_addc_co_u32 v5, vcc, v5, v5, vcc
    v_mov_b32 v6, v5
    s_nop 1
    v_permlane32_swap_b32 v6, v5
    v_lshl_or_b32 v5, v5, 16, v6
    v_cmp_eq_u32 vcc, 0, v5
    s_nop 1
    v_cndmask_b32 v5, v5, -1, vcc
    s_mov_b32 s55, vcc_lo
    v_bcnt_u32_b32 v6, v5, 0
    v_lshl_add_u32 v6, v6, 5, v2
    s_nop 0
    v_readlane_b32 s27, v5, s25
    v_readlane_b32 s56, v6, s25
    s_nop 1
    v_cmp_gt_u32 vcc, s56, v6
    s_nop 1
    s_bcnt1_i32_b32 s56, vcc_lo
    s_sub_u32 s56, 31, s56
    s_mov_b32 s30, 0
    s_movk_i32 s57, 0x400
L_bs:
    s_add_u32 s58, s30, s57
    v_cmp_gt_u32 vcc, s58, v6
    s_nop 1
    s_bcnt1_i32_b32 s59, vcc_lo
    s_cmp_le_u32 s59, s56
    s_cselect_b32 s30, s58, s30
    s_lshr_b32 s57, s57, 1
    s_cbranch_scc1 L_bs
    s_and_b32 s30, s30, 31
    v_readlane_b32 s32, v5, s30
    s_nop 1
    s_bcnt1_i32_b32 s28, s27
    s_bitcmp1_b32 s55, s25
    s_cselect_b32 s29, 0, 0x3db8aa3b
    s_bcnt1_i32_b32 s33, s32
    s_bitcmp1_b32 s55, s30
    s_cselect_b32 s34, 0, 0x3db8aa3b
    s_cmp_ge_u32 s24, 4
    s_cbranch_scc1 L_loader
    s_and_b32 s51, s24, 1
    s_lshr_b32 s52, s24, 1
    s_sub_u32 s42, s51, s52
    s_lshl_b32 s42, s42, 9
    s_mov_b32 s35, s28
    s_mov_b32 s36, s29
    s_mov_b32 s38, 33280
    s_mov_b32 s39, 33792
    s_mov_b32 s41, 0
    s_mov_b32 s47, 0x3f803f80
    s_sub_u32 s48, s29, 0x2000000
    s_max_i32 s48, s48, 0
    s_sub_u32 s49, s34, 0x2000000
    s_max_i32 s49, s49, 0
    s_lshl_b32 s43, s24, 9
    s_add_u32 s43, s43, 137216
    s_mul_i32 s44, s24, 8448
    s_xor_b32 s45, s24, 2
    s_mul_i32 s45, s45, 8448
    s_add_u32 s44, s44, 66560
    s_add_u32 s45, s45, 66560
    s_lshl_b32 s46, s51, 9
    s_lshl_b32 s54, s52, 8
    s_add_u32 s46, s46, s54
    v_and_b32 v10, 1, v2
    v_lshlrev_b32 v10, 4, v10
    v_mov_b32 v11, 0x3f80
    v_lshlrev_b32 v10, v10, v11
    v_bfe_u32 v11, v2, 2, 1
    v_cmp_eq_u32 vcc, v11, v3
    v_lshrrev_b32 v11, 3, v2
    v_bfe_u32 v12, v2, 1, 1
    v_cndmask_b32 v10, 0, v10, vcc
    v_lshl_add_u32 v11, v11, 1, v12
    v_cmp_eq_u32 vcc, 0, v11
    s_nop 1
    v_cndmask_b32 v16, 0, v10, vcc
    v_cmp_eq_u32 vcc, 1, v11
    s_nop 1
    v_cndmask_b32 v17, 0, v10, vcc
    v_cmp_eq_u32 vcc, 2, v11
    s_nop 1
    v_cndmask_b32 v18, 0, v10, vcc
    v_cmp_eq_u32 vcc, 3, v11
    s_nop 1
    v_cndmask_b32 v19, 0, v10, vcc
    v_cmp_eq_u32 vcc, 4, v11
    s_nop 1
    v_cndmask_b32 v20, 0, v10, vcc
    v_cmp_eq_u32 vcc, 5, v11
    s_nop 1
    v_cndmask_b32 v21, 0, v10, vcc
    v_cmp_eq_u32 vcc, 6, v11
    s_nop 1
    v_cndmask_b32 v22, 0, v10, vcc
    v_cmp_eq_u32 vcc, 7, v11
    s_nop 1
    v_cndmask_b32 v23, 0, v10, vcc
    v_lshlrev_b32 v12, 4, v8
    v_add_u32 v12, 139264, v12
    ds_write_b128 v12, v[16:19]
    ds_write_b128 v12, v[20:23] offset:1024
    v_mul_u32_u24 v1, 1040, v2
    v_lshl_add_u32 v1, v3, 4, v1
    s_lshl_b32 s53, s52, 9
    v_add_u32 v1, s53, v1
    v_bfe_u32 v12, v8, 2, 2
    v_lshl_add_u32 v12, v3, 2, v12
    v_mul_u32_u24 v12, 1056, v12
    v_bfe_u32 v13, v8, 4, 1
    v_lshl_add_u32 v12, v13, 4, v12
    v_bfe_u32 v13, v8, 1, 1
    v_lshl_add_u32 v12, v13, 3, v12
    v_and_b32 v13, 1, v8
    v_lshl_add_u32 v12, v13, 7, v12
    s_add_u32 s53, s53, 66560
    s_add_u32 s56, s54, s53
    v_add_u32 v3, s56, v12
    s_xor_b32 s54, s54, 0x100
    s_add_u32 s56, s54, s53
    v_add_u32 v2, s56, v12
    s_mov_b32 s56, 0x55555555
    s_mov_b32 s57, s56
    s_mov_b32 s58, 0x33333333
    s_mov_b32 s59, s58
    s_setprio 2
    s_waitcnt lgkmcnt(0)
    s_barrier
    v_add_u32 v232, s42, v1
    v_add_u32 v232, 66560, v232
    ds_read_b128 v[136:139], v232 offset:0
    ds_read_b128 v[140:143], v232 offset:32
    ds_read_b128 v[144:147], v232 offset:64
    ds_read_b128 v[148:151], v232 offset:96
    ds_read_b128 v[152:155], v232 offset:128
    ds_read_b128 v[156:159], v232 offset:160
    ds_read_b128 v[160:163], v232 offset:192
    ds_read_b128 v[164:167], v232 offset:224
    ds_read_b128 v[168:171], v232 offset:256
    ds_read_b128 v[172:175], v232 offset:288
    ds_read_b128 v[176:179], v232 offset:320
    ds_read_b128 v[180:183], v232 offset:352
    ds_read_b128 v[184:187], v232 offset:384
    ds_read_b128 v[188:191], v232 offset:416
    ds_read_b128 v[192:195], v232 offset:448
    s_waitcnt lgkmcnt(14)
    ds_read_b128 v[196:199], v232 offset:480
    v_add_u32 v2, s39, v2
    v_add_u32 v3, s39, v3
    s_sub_u32 s39, 0, s39
    v_add_u32 v1, s38, v1
    s_sub_u32 s38, 0, s38
    s_waitcnt lgkmcnt(0)
    s_barrier
    ds_read_b128 v[232:235], v1 offset:0
    ds_read_b128 v[236:239], v1 offset:32
    ds_read_b128 v[240:243], v1 offset:64
    ds_read_b128 v[244:247], v1 offset:96
    ds_read_b128 v[252:255], v1 offset:128
    v_add_u32 v2, s39, v2
    v_add_u32 v3, s39, v3
    s_sub_u32 s39, 0, s39
    s_waitcnt lgkmcnt(4)
    v_mfma_f32_32x32x16_bf16 v[200:215], v[232:235], v[136:139], 0
    ds_read_b128 v[232:235], v1 offset:160
    s_waitcnt lgkmcnt(4)
    v_mfma_f32_32x32x16_bf16 v[200:215], v[236:239], v[140:143], v[200:215]
    ds_read_b128 v[236:239], v1 offset:192
    s_waitcnt lgkmcnt(4)
    v_mfma_f32_32x32x16_bf16 v[200:215], v[240:243], v[144:147], v[200:215]
    ds_read_b128 v[240:243], v1 offset:224
    s_waitcnt lgkmcnt(3)
    v_mfma_f32_32x32x16_bf16 v[200:215], v[244:247], v[148:151], v[200:215]
    ds_read_b128 v[244:247], v1 offset:256
    ds_read_b128 v[248:251], v1 offset:288
    v_mfma_f32_32x32x16_bf16 v[200:215], v[252:255], v[152:155], v[200:215]
    ds_read_b128 v[252:255], v1 offset:320
    s_waitcnt lgkmcnt(4)
    v_mfma_f32_32x32x16_bf16 v[200:215], v[232:235], v[156:159], v[200:215]
    ds_read_b128 v[232:235], v1 offset:352
    v_mfma_f32_32x32x16_bf16 v[200:215], v[236:239], v[160:163], v[200:215]
    s_waitcnt lgkmcnt(2)
    v_mfma_f32_32x32x16_bf16 v[200:215], v[240:243], v[164:167], v[200:215]
    ds_read_b128 v[240:243], v1 offset:384
    v_mfma_f32_32x32x16_bf16 v[200:215], v[244:247], v[168:171], v[200:215]
    ds_read_b128 v[244:247], v1 offset:416
    v_mfma_f32_32x32x16_bf16 v[200:215], v[248:251], v[172:175], v[200:215]
    ds_read_b128 v[248:251], v1 offset:448
    s_waitcnt lgkmcnt(3)
    v_mfma_f32_32x32x16_bf16 v[200:215], v[252:255], v[176:179], v[200:215]
    ds_read_b128 v[252:255], v1 offset:480
    v_mfma_f32_32x32x16_bf16 v[200:215], v[232:235], v[180:183], v[200:215]
    s_waitcnt lgkmcnt(2)
    v_mfma_f32_32x32x16_bf16 v[200:215], v[240:243], v[184:187], v[200:215]
    s_waitcnt lgkmcnt(0)
    s_barrier
    v_mfma_f32_32x32x16_bf16 v[200:215], v[244:247], v[188:191], v[200:215]
    v_mfma_f32_32x32x16_bf16 v[200:215], v[248:251], v[192:195], v[200:215]
    v_mfma_f32_32x32x16_bf16 v[200:215], v[252:255], v[196:199], v[200:215]
    v_add_u32 v1, s38, v1
    s_sub_u32 s38, 0, s38
    s_nop 9
    v_max3_f32 v6, v200, v201, v202
    v_max3_f32 v6, v6, v203, v204
    v_max3_f32 v6, v6, v205, v206
    v_max3_f32 v6, v6, v207, v208
    v_max3_f32 v6, v6, v209, v210
    v_max3_f32 v6, v6, v211, v212
    v_max3_f32 v6, v6, v213, v214
    v_max_f32 v6, v6, v215
    v_mov_b32 v224, v6
    v_mov_b32 v5, 0
    s_nop 0
    v_permlane32_swap_b32 v224, v6
    v_max_f32 v6, v6, v224
    v_mul_f32 v4, s48, v6
    v_rndne_f32 v4, v4
    v_mul_f32 v4, 0x41800000, v4
    v_fma_f32 v200, v200, s36, -v4
    v_fma_f32 v201, v201, s36, -v4
    v_fma_f32 v202, v202, s36, -v4
    v_exp_f32 v200, v200
    v_fma_f32 v203, v203, s36, -v4
    v_exp_f32 v201, v201
    v_fma_f32 v204, v204, s36, -v4
    v_exp_f32 v202, v202
    v_add_f32 v5, v5, v200
    v_fma_f32 v205, v205, s36, -v4
    v_exp_f32 v203, v203
    v_add_f32 v5, v5, v201
    v_fma_f32 v206, v206, s36, -v4
    v_exp_f32 v204, v204
    v_add_f32 v5, v5, v202
    v_fma_f32 v207, v207, s36, -v4
    v_exp_f32 v205, v205
    v_add_f32 v5, v5, v203
    v_exp_f32 v206, v206
    v_add_f32 v5, v5, v204
    v_exp_f32 v207, v207
    v_add_f32 v5, v5, v205
    v_add_f32 v5, v5, v206
    v_add_f32 v5, v5, v207
    v_fma_f32 v224, v208, s36, -v4
    v_fma_f32 v225, v209, s36, -v4
    v_fma_f32 v226, v210, s36, -v4
    v_fma_f32 v227, v211, s36, -v4
    v_fma_f32 v228, v212, s36, -v4
    v_fma_f32 v229, v213, s36, -v4
    v_fma_f32 v230, v214, s36, -v4
    v_fma_f32 v231, v215, s36, -v4
    v_cvt_pk_bf16_f32 v216, v200, v201
    v_cvt_pk_bf16_f32 v217, v202, v203
    v_cvt_pk_bf16_f32 v218, v204, v205
    v_cvt_pk_bf16_f32 v219, v206, v207
    s_waitcnt lgkmcnt(0)
    s_barrier
L_item:
    s_cmp_eq_u32 s35, 1
    s_cbranch_scc1 L_xd1
    ds_read_b128 v[232:235], v1 offset:0
    ds_read_b128 v[236:239], v1 offset:32
    ds_read_b128 v[240:243], v1 offset:64
    ds_read_b128 v[244:247], v1 offset:96
    ds_read_b128 v[252:255], v1 offset:128
    s_waitcnt lgkmcnt(4)
    v_mfma_f32_32x32x16_bf16 v[200:215], v[232:235], v[136:139], 0
    ds_read_b128 v[232:235], v1 offset:160
    v_add_u32 v2, s39, v2
    v_add_u32 v3, s39, v3
    s_sub_u32 s39, 0, s39
    s_waitcnt lgkmcnt(4)
    v_mfma_f32_32x32x16_bf16 v[200:215], v[236:239], v[140:143], v[200:215]
    ds_read_b128 v[236:239], v1 offset:192
    v_exp_f32 v224, v224
    s_waitcnt lgkmcnt(4)
    v_mfma_f32_32x32x16_bf16 v[200:215], v[240:243], v[144:147], v[200:215]
    ds_read_b128 v[240:243], v1 offset:224
    v_exp_f32 v225, v225
    s_waitcnt lgkmcnt(3)
    v_mfma_f32_32x32x16_bf16 v[200:215], v[244:247], v[148:151], v[200:215]
    ds_read_b128 v[244:247], v1 offset:256
    ds_read_b128 v[248:251], v1 offset:288
    v_exp_f32 v226, v226
    v_mfma_f32_32x32x16_bf16 v[200:215], v[252:255], v[152:155], v[200:215]
    ds_read_b128 v[252:255], v1 offset:320
    v_add_f32 v5, v5, v224
    v_exp_f32 v227, v227
    s_waitcnt lgkmcnt(4)
    v_mfma_f32_32x32x16_bf16 v[200:215], v[232:235], v[156:159], v[200:215]
    ds_read_b128 v[232:235], v1 offset:352
    v_add_f32 v5, v5, v225
    v_exp_f32 v228, v228
    v_mfma_f32_32x32x16_bf16 v[200:215], v[236:239], v[160:163], v[200:215]
    v_add_f32 v5, v5, v226
    v_exp_f32 v229, v229
    s_waitcnt lgkmcnt(2)
    v_mfma_f32_32x32x16_bf16 v[200:215], v[240:243], v[164:167], v[200:215]
    ds_read_b128 v[240:243], v1 offset:384
    v_add_f32 v5, v5, v227
    v_exp_f32 v230, v230
    v_mfma_f32_32x32x16_bf16 v[200:215], v[244:247], v[168:171], v[200:215]
    ds_read_b128 v[244:247], v1 offset:416
    v_add_f32 v5, v5, v228
    v_mfma_f32_32x32x16_bf16 v[200:215], v[248:251], v[172:175], v[200:215]
    ds_read_b128 v[248:251], v1 offset:448
    v_exp_f32 v231, v231
    v_add_f32 v5, v5, v229
    s_waitcnt lgkmcnt(3)
    v_mfma_f32_32x32x16_bf16 v[200:215], v[252:255], v[176:179], v[200:215]
    ds_read_b128 v[252:255], v1 offset:480
    v_add_f32 v5, v5, v230
    v_add_f32 v5, v5, v231
    v_cvt_pk_bf16_f32 v220, v224, v225
    v_mfma_f32_32x32x16_bf16 v[200:215], v[232:235], v[180:183], v[200:215]
    v_cvt_pk_bf16_f32 v221, v226, v227
    v_cvt_pk_bf16_f32 v222, v228, v229
    v_cvt_pk_bf16_f32 v223, v230, v231
    s_waitcnt lgkmcnt(2)
    v_mfma_f32_32x32x16_bf16 v[200:215], v[240:243], v[184:187], v[200:215]
    s_waitcnt lgkmcnt(0)
    s_barrier
    ds_read_b64_tr_b16 v[232:233], v2 offset:0
    ds_read_b64_tr_b16 v[234:235], v2 offset:8448
    v_mfma_f32_32x32x16_bf16 v[200:215], v[244:247], v[188:191], v[200:215]
    ds_read_b64_tr_b16 v[236:237], v2 offset:32
    ds_read_b64_tr_b16 v[238:239], v2 offset:8480
    ds_read_b64_tr_b16 v[240:241], v2 offset:64
    ds_read_b64_tr_b16 v[242:243], v2 offset:8512
    v_mfma_f32_32x32x16_bf16 v[200:215], v[248:251], v[192:195], v[200:215]
    ds_read_b64_tr_b16 v[244:245], v2 offset:96
    ds_read_b64_tr_b16 v[246:247], v2 offset:8544
    v_mfma_f32_32x32x16_bf16 v[200:215], v[252:255], v[196:199], v[200:215]
    ds_read_b64_tr_b16 v[252:253], v3 offset:0
    ds_read_b64_tr_b16 v[254:255], v3 offset:8448
    v_add_u32 v1, s38, v1
    s_sub_u32 s38, 0, s38
    s_waitcnt lgkmcnt(8)
    v_mfma_f32_32x32x16_bf16 v[8:23], v[232:235], v[216:219], 0
    ds_read_b64_tr_b16 v[232:233], v3 offset:32
    ds_read_b64_tr_b16 v[234:235], v3 offset:8480
    s_mov_b32 s40, 2
    s_cmp_eq_u32 s35, 2
    s_waitcnt lgkmcnt(6)
    v_mfma_f32_32x32x16_bf16 v[24:39], v[236:239], v[216:219], 0
    ds_read_b64_tr_b16 v[236:237], v3 offset:64
    ds_read_b64_tr_b16 v[238:239], v3 offset:8512
    v_max3_f32 v6, v200, v201, v202
    v_max3_f32 v6, v6, v203, v204
    v_max3_f32 v6, v6, v205, v206
    v_max3_f32 v6, v6, v207, v208
    v_mfma_f32_32x32x16_bf16 v[40:55], v[240:243], v[216:219], 0
    ds_read_b64_tr_b16 v[240:241], v3 offset:96
    ds_read_b64_tr_b16 v[242:243], v3 offset:8544
    v_max3_f32 v6, v6, v209, v210
    v_max3_f32 v6, v6, v211, v212
    v_max3_f32 v6, v6, v213, v214
    s_waitcnt lgkmcnt(6)
    v_mfma_f32_32x32x16_bf16 v[56:71], v[244:247], v[216:219], 0
    ds_read_b64_tr_b16 v[244:245], v2 offset:16896
    ds_read_b64_tr_b16 v[246:247], v2 offset:25344
    ds_read_b64_tr_b16 v[248:249], v2 offset:16928
    ds_read_b64_tr_b16 v[250:251], v2 offset:25376
    v_max_f32 v6, v6, v215
    v_fma_f32 v6, v6, s36, -v4
    v_mfma_f32_32x32x16_bf16 v[72:87], v[252:255], v[216:219], 0
    ds_read_b64_tr_b16 v[252:253], v2 offset:16960
    ds_read_b64_tr_b16 v[254:255], v2 offset:25408
    v_cmp_lt_f32 vcc, 0x41000000, v6
    s_cbranch_vccnz L_rare_yc1
L_ret_yc1:
    v_fma_f32 v200, v200, s36, -v4
    v_fma_f32 v201, v201, s36, -v4
    s_waitcnt lgkmcnt(8)
    v_mfma_f32_32x32x16_bf16 v[88:103], v[232:235], v[216:219], 0
    ds_read_b64_tr_b16 v[232:233], v2 offset:16992
    ds_read_b64_tr_b16 v[234:235], v2 offset:25440
    v_fma_f32 v202, v202, s36, -v4
    v_exp_f32 v200, v200
    v_fma_f32 v203, v203, s36, -v4
    v_mfma_f32_32x32x16_bf16 v[104:119], v[236:239], v[216:219], 0
    v_exp_f32 v201, v201
    v_fma_f32 v204, v204, s36, -v4
    v_exp_f32 v202, v202
    s_waitcnt lgkmcnt(4)
    v_mfma_f32_32x32x16_bf16 v[120:135], v[240:243], v[216:219], 0
    ds_read_b64_tr_b16 v[240:241], v3 offset:16896
    ds_read_b64_tr_b16 v[242:243], v3 offset:25344
    v_add_f32 v5, v5, v200
    v_fma_f32 v205, v205, s36, -v4
    v_exp_f32 v203, v203
    v_mfma_f32_32x32x16_bf16 v[8:23], v[244:247], v[220:223], v[8:23]
    ds_read_b64_tr_b16 v[244:245], v3 offset:16928
    ds_read_b64_tr_b16 v[246:247], v3 offset:25376
    v_add_f32 v5, v5, v201
    v_fma_f32 v206, v206, s36, -v4
    v_exp_f32 v204, v204
    v_mfma_f32_32x32x16_bf16 v[24:39], v[248:251], v[220:223], v[24:39]
    ds_read_b64_tr_b16 v[248:249], v3 offset:16960
    ds_read_b64_tr_b16 v[250:251], v3 offset:25408
    v_add_f32 v5, v5, v202
    v_fma_f32 v207, v207, s36, -v4
    v_exp_f32 v205, v205
    s_waitcnt lgkmcnt(6)
    v_mfma_f32_32x32x16_bf16 v[40:55], v[252:255], v[220:223], v[40:55]
    ds_read_b64_tr_b16 v[252:253], v3 offset:16992
    ds_read_b64_tr_b16 v[254:255], v3 offset:25440
    v_add_f32 v5, v5, v203
    v_exp_f32 v206, v206
    v_mfma_f32_32x32x16_bf16 v[56:71], v[232:235], v[220:223], v[56:71]
    v_add_f32 v5, v5, v204
    v_exp_f32 v207, v207
    v_add_f32 v5, v5, v205
    v_add_f32 v5, v5, v206
    v_add_f32 v5, v5, v207
    s_waitcnt lgkmcnt(4)
    v_mfma_f32_32x32x16_bf16 v[72:87], v[240:243], v[220:223], v[72:87]
    s_waitcnt lgkmcnt(0)
    s_barrier
    s_cbranch_scc1 L_xd
L_loop:
    ds_read_b128 v[232:235], v1 offset:0
    ds_read_b128 v[236:239], v1 offset:32
    v_mfma_f32_32x32x16_bf16 v[88:103], v[244:247], v[220:223], v[88:103]
    ds_read_b128 v[240:243], v1 offset:64
    ds_read_b128 v[244:247], v1 offset:96
    v_fma_f32 v224, v208, s36, -v4
    v_fma_f32 v225, v209, s36, -v4
    v_fma_f32 v226, v210, s36, -v4
    v_mfma_f32_32x32x16_bf16 v[104:119], v[248:251], v[220:223], v[104:119]
    v_fma_f32 v227, v211, s36, -v4
    v_fma_f32 v228, v212, s36, -v4
    v_fma_f32 v229, v213, s36, -v4
    v_fma_f32 v230, v214, s36, -v4
    v_fma_f32 v231, v215, s36, -v4
    v_cvt_pk_bf16_f32 v216, v200, v201
    v_mfma_f32_32x32x16_bf16 v[120:135], v[252:255], v[220:223], v[120:135]
    ds_read_b128 v[252:255], v1 offset:128
    v_cvt_pk_bf16_f32 v217, v202, v203
    v_cvt_pk_bf16_f32 v218, v204, v205
    v_cvt_pk_bf16_f32 v219, v206, v207
    s_cbranch_vccnz L_rare_xc
L_ret_xc:
    s_waitcnt lgkmcnt(3)
    v_mfma_f32_32x32x16_bf16 v[200:215], v[232:235], v[136:139], 0
    ds_read_b128 v[232:235], v1 offset:160
    v_add_u32 v2, s39, v2
    v_add_u32 v3, s39, v3
    s_sub_u32 s39, 0, s39
    v_mfma_f32_32x32x16_bf16 v[200:215], v[236:239], v[140:143], v[200:215]
    ds_read_b128 v[236:239], v1 offset:192
    v_exp_f32 v224, v224
    s_waitcnt lgkmcnt(3)
    v_mfma_f32_32x32x16_bf16 v[200:215], v[240:243], v[144:147], v[200:215]
    ds_read_b128 v[240:243], v1 offset:224
    v_exp_f32 v225, v225
    v_mfma_f32_32x32x16_bf16 v[200:215], v[244:247], v[148:151], v[200:215]
    ds_read_b128 v[244:247], v1 offset:256
    ds_read_b128 v[248:251], v1 offset:288
    v_exp_f32 v226, v226
    s_waitcnt lgkmcnt(4)
    v_mfma_f32_32x32x16_bf16 v[200:215], v[252:255], v[152:155], v[200:215]
    ds_read_b128 v[252:255], v1 offset:320
    v_add_f32 v5, v5, v224
    v_exp_f32 v227, v227
    v_mfma_f32_32x32x16_bf16 v[200:215], v[232:235], v[156:159], v[200:215]
    ds_read_b128 v[232:235], v1 offset:352
    v_add_f32 v5, v5, v225
    v_exp_f32 v228, v228
    s_waitcnt lgkmcnt(4)
    v_mfma_f32_32x32x16_bf16 v[200:215], v[236:239], v[160:163], v[200:215]
    v_add_f32 v5, v5, v226
    v_exp_f32 v229, v229
    v_mfma_f32_32x32x16_bf16 v[200:215], v[240:243], v[164:167], v[200:215]
    ds_read_b128 v[240:243], v1 offset:384
    v_add_f32 v5, v5, v227
    v_exp_f32 v230, v230
    s_waitcnt lgkmcnt(2)
    v_mfma_f32_32x32x16_bf16 v[200:215], v[244:247], v[168:171], v[200:215]
    ds_read_b128 v[244:247], v1 offset:416
    v_add_f32 v5, v5, v228
    v_mfma_f32_32x32x16_bf16 v[200:215], v[248:251], v[172:175], v[200:215]
    ds_read_b128 v[248:251], v1 offset:448
    v_exp_f32 v231, v231
    v_add_f32 v5, v5, v229
    v_mfma_f32_32x32x16_bf16 v[200:215], v[252:255], v[176:179], v[200:215]
    ds_read_b128 v[252:255], v1 offset:480
    v_add_f32 v5, v5, v230
    v_add_f32 v5, v5, v231
    v_cvt_pk_bf16_f32 v220, v224, v225
    s_waitcnt lgkmcnt(3)
    v_mfma_f32_32x32x16_bf16 v[200:215], v[232:235], v[180:183], v[200:215]
    v_cvt_pk_bf16_f32 v221, v226, v227
    v_cvt_pk_bf16_f32 v222, v228, v229
    v_cvt_pk_bf16_f32 v223, v230, v231
    v_mfma_f32_32x32x16_bf16 v[200:215], v[240:243], v[184:187], v[200:215]
    s_waitcnt lgkmcnt(0)
    s_barrier
    ds_read_b64_tr_b16 v[232:233], v2 offset:0
    ds_read_b64_tr_b16 v[234:235], v2 offset:8448
    v_mfma_f32_32x32x16_bf16 v[200:215], v[244:247], v[188:191], v[200:215]
    ds_read_b64_tr_b16 v[236:237], v2 offset:32
    ds_read_b64_tr_b16 v[238:239], v2 offset:8480
    ds_read_b64_tr_b16 v[240:241], v2 offset:64
    ds_read_b64_tr_b16 v[242:243], v2 offset:8512
    v_mfma_f32_32x32x16_bf16 v[200:215], v[248:251], v[192:195], v[200:215]
    ds_read_b64_tr_b16 v[244:245], v2 offset:96
    ds_read_b64_tr_b16 v[246:247], v2 offset:8544
    v_mfma_f32_32x32x16_bf16 v[200:215], v[252:255], v[196:199], v[200:215]
    ds_read_b64_tr_b16 v[252:253], v3 offset:0
    ds_read_b64_tr_b16 v[254:255], v3 offset:8448
    v_add_u32 v1, s38, v1
    s_sub_u32 s38, 0, s38
    s_waitcnt lgkmcnt(8)
    v_mfma_f32_32x32x16_bf16 v[8:23], v[232:235], v[216:219], v[8:23]
    ds_read_b64_tr_b16 v[232:233], v3 offset:32
    ds_read_b64_tr_b16 v[234:235], v3 offset:8480
    s_add_u32 s40, s40, 1
    s_cmp_lt_u32 s40, s35
    s_waitcnt lgkmcnt(6)
    v_mfma_f32_32x32x16_bf16 v[24:39], v[236:239], v[216:219], v[24:39]
    ds_read_b64_tr_b16 v[236:237], v3 offset:64
    ds_read_b64_tr_b16 v[238:239], v3 offset:8512
    v_max3_f32 v6, v200, v201, v202
    v_max3_f32 v6, v6, v203, v204
    v_max3_f32 v6, v6, v205, v206
    v_max3_f32 v6, v6, v207, v208
    v_mfma_f32_32x32x16_bf16 v[40:55], v[240:243], v[216:219], v[40:55]
    ds_read_b64_tr_b16 v[240:241], v3 offset:96
    ds_read_b64_tr_b16 v[242:243], v3 offset:8544
    v_max3_f32 v6, v6, v209, v210
    v_max3_f32 v6, v6, v211, v212
    v_max3_f32 v6, v6, v213, v214
    s_waitcnt lgkmcnt(6)
    v_mfma_f32_32x32x16_bf16 v[56:71], v[244:247], v[216:219], v[56:71]
    ds_read_b64_tr_b16 v[244:245], v2 offset:16896
    ds_read_b64_tr_b16 v[246:247], v2 offset:25344
    ds_read_b64_tr_b16 v[248:249], v2 offset:16928
    ds_read_b64_tr_b16 v[250:251], v2 offset:25376
    v_max_f32 v6, v6, v215
    v_fma_f32 v6, v6, s36, -v4
    v_mfma_f32_32x32x16_bf16 v[72:87], v[252:255], v[216:219], v[72:87]
    ds_read_b64_tr_b16 v[252:253], v2 offset:16960
    ds_read_b64_tr_b16 v[254:255], v2 offset:25408
    v_cmp_lt_f32 vcc, 0x41000000, v6
    s_cbranch_vccnz L_rare_yc
L_ret_yc:
    v_fma_f32 v200, v200, s36, -v4
    v_fma_f32 v201, v201, s36, -v4
    s_waitcnt lgkmcnt(8)
    v_mfma_f32_32x32x16_bf16 v[88:103], v[232:235], v[216:219], v[88:103]
    ds_read_b64_tr_b16 v[232:233], v2 offset:16992
    ds_read_b64_tr_b16 v[234:235], v2 offset:25440
    v_fma_f32 v202, v202, s36, -v4
    v_exp_f32 v200, v200
    v_fma_f32 v203, v203, s36, -v4
    v_mfma_f32_32x32x16_bf16 v[104:119], v[236:239], v[216:219], v[104:119]
    v_exp_f32 v201, v201
    v_fma_f32 v204, v204, s36, -v4
    v_exp_f32 v202, v202
    s_waitcnt lgkmcnt(4)
    v_mfma_f32_32x32x16_bf16 v[120:135], v[240:243], v[216:219], v[120:135]
    ds_read_b64_tr_b16 v[240:241], v3 offset:16896
    ds_read_b64_tr_b16 v[242:243], v3 offset:25344
    v_add_f32 v5, v5, v200
    v_fma_f32 v205, v205, s36, -v4
    v_exp_f32 v203, v203
    v_mfma_f32_32x32x16_bf16 v[8:23], v[244:247], v[220:223], v[8:23]
    ds_read_b64_tr_b16 v[244:245], v3 offset:16928
    ds_read_b64_tr_b16 v[246:247], v3 offset:25376
    v_add_f32 v5, v5, v201
    v_fma_f32 v206, v206, s36, -v4
    v_exp_f32 v204, v204
    v_mfma_f32_32x32x16_bf16 v[24:39], v[248:251], v[220:223], v[24:39]
    ds_read_b64_tr_b16 v[248:249], v3 offset:16960
    ds_read_b64_tr_b16 v[250:251], v3 offset:25408
    v_add_f32 v5, v5, v202
    v_fma_f32 v207, v207, s36, -v4
    v_exp_f32 v205, v205
    s_waitcnt lgkmcnt(6)
    v_mfma_f32_32x32x16_bf16 v[40:55], v[252:255], v[220:223], v[40:55]
    ds_read_b64_tr_b16 v[252:253], v3 offset:16992
    ds_read_b64_tr_b16 v[254:255], v3 offset:25440
    v_add_f32 v5, v5, v203
    v_exp_f32 v206, v206
    v_mfma_f32_32x32x16_bf16 v[56:71], v[232:235], v[220:223], v[56:71]
    v_add_f32 v5, v5, v204
    v_exp_f32 v207, v207
    v_add_f32 v5, v5, v205
    v_add_f32 v5, v5, v206
    v_add_f32 v5, v5, v207
    s_waitcnt lgkmcnt(4)
    v_mfma_f32_32x32x16_bf16 v[72:87], v[240:243], v[220:223], v[72:87]
    s_waitcnt lgkmcnt(0)
    s_barrier
    s_cbranch_scc1 L_loop
L_xd:
    s_cmp_eq_u32 s41, 1
    s_cbranch_scc1 L_zd
    v_add_u32 v232, s42, v1
    ds_read_b128 v[136:139], v232 offset:0
    ds_read_b128 v[140:143], v232 offset:32
    v_mfma_f32_32x32x16_bf16 v[88:103], v[244:247], v[220:223], v[88:103]
    ds_read_b128 v[144:147], v232 offset:64
    ds_read_b128 v[148:151], v232 offset:96
    v_fma_f32 v224, v208, s36, -v4
    v_fma_f32 v225, v209, s36, -v4
    v_fma_f32 v226, v210, s36, -v4
    v_fma_f32 v227, v211, s36, -v4
    v_mfma_f32_32x32x16_bf16 v[104:119], v[248:251], v[220:223], v[104:119]
    ds_read_b128 v[152:155], v232 offset:128
    ds_read_b128 v[156:159], v232 offset:160
    v_fma_f32 v228, v212, s36, -v4
    v_fma_f32 v229, v213, s36, -v4
    v_fma_f32 v230, v214, s36, -v4
    v_fma_f32 v231, v215, s36, -v4
    v_mfma_f32_32x32x16_bf16 v[120:135], v[252:255], v[220:223], v[120:135]
    ds_read_b128 v[160:163], v232 offset:192
    ds_read_b128 v[164:167], v232 offset:224
    v_cvt_pk_bf16_f32 v216, v200, v201
    v_cvt_pk_bf16_f32 v217, v202, v203
    v_cvt_pk_bf16_f32 v218, v204, v205
    v_cvt_pk_bf16_f32 v219, v206, v207
    v_add_u32 v2, s39, v2
    v_add_u32 v3, s39, v3
    s_sub_u32 s39, 0, s39
    s_cbranch_vccnz L_rare_xd
L_ret_xd:
    v_exp_f32 v224, v224
    v_exp_f32 v225, v225
    ds_read_b128 v[168:171], v232 offset:256
    v_exp_f32 v226, v226
    v_add_f32 v5, v5, v224
    ds_read_b128 v[172:175], v232 offset:288
    v_exp_f32 v227, v227
    v_add_f32 v5, v5, v225
    ds_read_b128 v[176:179], v232 offset:320
    v_exp_f32 v228, v228
    v_add_f32 v5, v5, v226
    ds_read_b128 v[180:183], v232 offset:352
    v_exp_f32 v229, v229
    v_add_f32 v5, v5, v227
    ds_read_b128 v[184:187], v232 offset:384
    v_exp_f32 v230, v230
    v_add_f32 v5, v5, v228
    ds_read_b128 v[188:191], v232 offset:416
    v_exp_f32 v231, v231
    v_add_f32 v5, v5, v229
    ds_read_b128 v[192:195], v232 offset:448
    v_add_f32 v5, v5, v230
    v_add_f32 v5, v5, v231
    s_waitcnt lgkmcnt(6)
    ds_read_b128 v[196:199], v232 offset:480
    v_cvt_pk_bf16_f32 v220, v224, v225
    v_cvt_pk_bf16_f32 v221, v226, v227
    v_cvt_pk_bf16_f32 v222, v228, v229
    v_cvt_pk_bf16_f32 v223, v230, v231
    v_mov_b32 v224, v5
    v_mbcnt_lo_u32_b32 v6, -1, 0
    v_mbcnt_hi_u32_b32 v6, -1, v6
    v_permlane32_swap_b32 v224, v5
    v_lshl_add_u32 v6, v6, 3, s43
    v_add_f32 v5, v5, v224
    ds_write_b64 v6, v[4:5]
    v_xor_b32 v6, 0x400, v6
    s_waitcnt lgkmcnt(0)
    s_barrier
    ds_read_b64_tr_b16 v[232:233], v2 offset:0
    ds_read_b64_tr_b16 v[234:235], v2 offset:8448
    ds_read_b64_tr_b16 v[236:237], v2 offset:32
    ds_read_b64_tr_b16 v[238:239], v2 offset:8480
    ds_read_b64_tr_b16 v[240:241], v2 offset:64
    ds_read_b64_tr_b16 v[242:243], v2 offset:8512
    ds_read_b64_tr_b16 v[244:245], v2 offset:96
    ds_read_b64_tr_b16 v[246:247], v2 offset:8544
    ds_read_b64_tr_b16 v[252:253], v3 offset:0
    ds_read_b64_tr_b16 v[254:255], v3 offset:8448
    v_add_u32 v1, s38, v1
    s_sub_u32 s38, 0, s38
    s_waitcnt lgkmcnt(8)
    v_mfma_f32_32x32x16_bf16 v[8:23], v[232:235], v[216:219], v[8:23]
    ds_read_b64_tr_b16 v[232:233], v3 offset:32
    ds_read_b64_tr_b16 v[234:235], v3 offset:8480
    s_waitcnt lgkmcnt(8)
    v_mfma_f32_32x32x16_bf16 v[24:39], v[236:239], v[216:219], v[24:39]
    ds_read_b64_tr_b16 v[236:237], v3 offset:64
    ds_read_b64_tr_b16 v[238:239], v3 offset:8512
    ds_read_b64 v[224:225], v6
    s_waitcnt lgkmcnt(9)
    v_mfma_f32_32x32x16_bf16 v[40:55], v[240:243], v[216:219], v[40:55]
    ds_read_b64_tr_b16 v[240:241], v3 offset:96
    ds_read_b64_tr_b16 v[242:243], v3 offset:8544
    s_waitcnt lgkmcnt(7)
    v_mfma_f32_32x32x16_bf16 v[56:71], v[244:247], v[216:219], v[56:71]
    ds_read_b64_tr_b16 v[244:245], v2 offset:16896
    ds_read_b64_tr_b16 v[246:247], v2 offset:25344
    ds_read_b64_tr_b16 v[248:249], v2 offset:16928
    ds_read_b64_tr_b16 v[250:251], v2 offset:25376
    v_mfma_f32_32x32x16_bf16 v[72:87], v[252:255], v[216:219], v[72:87]
    ds_read_b64_tr_b16 v[252:253], v2 offset:16960
    ds_read_b64_tr_b16 v[254:255], v2 offset:25408
    s_waitcnt lgkmcnt(8)
    v_mfma_f32_32x32x16_bf16 v[88:103], v[232:235], v[216:219], v[88:103]
    ds_read_b64_tr_b16 v[232:233], v2 offset:16992
    ds_read_b64_tr_b16 v[234:235], v2 offset:25440
    v_cmp_neq_f32 vcc, v4, v224
    v_max_f32 v226, v4, v224
    v_mfma_f32_32x32x16_bf16 v[104:119], v[236:239], v[216:219], v[104:119]
    v_sub_f32 v227, v4, v226
    v_sub_f32 v224, v224, v226
    v_exp_f32 v227, v227
    s_waitcnt lgkmcnt(4)
    v_mfma_f32_32x32x16_bf16 v[120:135], v[240:243], v[216:219], v[120:135]
    ds_read_b64_tr_b16 v[240:241], v3 offset:16896
    ds_read_b64_tr_b16 v[242:243], v3 offset:25344
    v_exp_f32 v224, v224
    v_mfma_f32_32x32x16_bf16 v[8:23], v[244:247], v[220:223], v[8:23]
    ds_read_b64_tr_b16 v[244:245], v3 offset:16928
    ds_read_b64_tr_b16 v[246:247], v3 offset:25376
    v_mul_f32 v5, v5, v227
    v_fmac_f32 v5, v224, v225
    v_mfma_f32_32x32x16_bf16 v[24:39], v[248:251], v[220:223], v[24:39]
    ds_read_b64_tr_b16 v[248:249], v3 offset:16960
    ds_read_b64_tr_b16 v[250:251], v3 offset:25408
    v_rcp_f32 v7, v5
    s_waitcnt lgkmcnt(6)
    v_mfma_f32_32x32x16_bf16 v[40:55], v[252:255], v[220:223], v[40:55]
    ds_read_b64_tr_b16 v[252:253], v3 offset:16992
    ds_read_b64_tr_b16 v[254:255], v3 offset:25440
    v_mbcnt_lo_u32_b32 v229, -1, 0
    v_mbcnt_hi_u32_b32 v229, -1, v229
    v_mfma_f32_32x32x16_bf16 v[56:71], v[232:235], v[220:223], v[56:71]
    s_sub_u32 s51, 0, s39
    s_max_i32 s51, s51, 0
    s_add_u32 s52, s51, s45
    s_add_u32 s51, s51, s44
    s_waitcnt lgkmcnt(4)
    v_mfma_f32_32x32x16_bf16 v[72:87], v[240:243], v[220:223], v[72:87]
    v_lshl_add_u32 v224, v229, 4, s52
    v_lshl_add_u32 v225, v229, 4, s51
    v_lshlrev_b32 v226, 4, v229
    v_add_u32 v226, 139264, v226
    s_waitcnt lgkmcnt(0)
    s_barrier
L_e:
    s_cmp_eq_u32 s41, 1
    s_cbranch_scc1 L_fin
    ds_read_b128 v[232:235], v1 offset:0
    ds_read_b128 v[236:239], v1 offset:32
    v_mfma_f32_32x32x16_bf16 v[88:103], v[244:247], v[220:223], v[88:103]
    ds_read_b128 v[240:243], v1 offset:64
    ds_read_b128 v[244:247], v1 offset:96
    v_and_b32 v6, 24, v229
    v_mfma_f32_32x32x16_bf16 v[104:119], v[248:251], v[220:223], v[104:119]
    v_lshrrev_b32 v231, 5, v229
    v_lshl_add_u32 v6, v6, 10, s46
    v_lshl_add_u32 v6, v231, 7, v6
    v_mfma_f32_32x32x16_bf16 v[120:135], v[252:255], v[220:223], v[120:135]
    ds_read_b128 v[252:255], v1 offset:128
    v_and_b32 v231, 7, v229
    v_lshl_add_u32 v6, v231, 4, v6
    s_cbranch_vccnz L_rare_xe
L_ret_xe:
    s_waitcnt lgkmcnt(3)
    v_mfma_f32_32x32x16_bf16 v[200:215], v[232:235], v[136:139], 0
    ds_read_b128 v[232:235], v1 offset:160
    ds_read_b128 v[216:219], v226 offset:0
    ds_read_b128 v[220:223], v226 offset:1024
    v_cvt_pk_bf16_f32 v8, v8, v9
    v_cvt_pk_bf16_f32 v9, v10, v11
    v_mfma_f32_32x32x16_bf16 v[200:215], v[236:239], v[140:143], v[200:215]
    ds_read_b128 v[236:239], v1 offset:192
    v_cvt_pk_bf16_f32 v10, v12, v13
    v_cvt_pk_bf16_f32 v11, v14, v15
    v_cvt_pk_bf16_f32 v12, v16, v17
    v_cvt_pk_bf16_f32 v13, v18, v19
    s_waitcnt lgkmcnt(5)
    v_mfma_f32_32x32x16_bf16 v[200:215], v[240:243], v[144:147], v[200:215]
    ds_read_b128 v[240:243], v1 offset:224
    ds_write_b128 v224, v[8:11] offset:0
    v_cvt_pk_bf16_f32 v14, v20, v21
    v_cvt_pk_bf16_f32 v15, v22, v23
    v_mfma_f32_32x32x16_bf16 v[200:215], v[244:247], v[148:151], v[200:215]
    ds_read_b128 v[244:247], v1 offset:256
    ds_read_b128 v[248:251], v1 offset:288
    v_cvt_pk_bf16_f32 v24, v24, v25
    v_cvt_pk_bf16_f32 v25, v26, v27
    ds_write_b128 v224, v[12:15] offset:1024
    s_waitcnt lgkmcnt(6)
    v_mfma_f32_32x32x16_bf16 v[200:215], v[252:255], v[152:155], v[200:215]
    ds_read_b128 v[252:255], v1 offset:320
    v_cvt_pk_bf16_f32 v26, v28, v29
    v_cvt_pk_bf16_f32 v27, v30, v31
    v_cvt_pk_bf16_f32 v28, v32, v33
    v_cvt_pk_bf16_f32 v29, v34, v35
    v_mfma_f32_32x32x16_bf16 v[200:215], v[232:235], v[156:159], v[200:215]
    ds_read_b128 v[232:235], v1 offset:352
    ds_write_b128 v224, v[24:27] offset:2048
    v_cvt_pk_bf16_f32 v30, v36, v37
    v_cvt_pk_bf16_f32 v31, v38, v39
    v_cvt_pk_bf16_f32 v40, v40, v41
    s_waitcnt lgkmcnt(6)
    v_mfma_f32_32x32x16_bf16 v[200:215], v[236:239], v[160:163], v[200:215]
    v_cvt_pk_bf16_f32 v41, v42, v43
    ds_write_b128 v224, v[28:31] offset:3072
    v_cvt_pk_bf16_f32 v42, v44, v45
    v_cvt_pk_bf16_f32 v43, v46, v47
    v_cvt_pk_bf16_f32 v44, v48, v49
    v_mfma_f32_32x32x16_bf16 v[200:215], v[240:243], v[164:167], v[200:215]
    ds_read_b128 v[240:243], v1 offset:384
    v_cvt_pk_bf16_f32 v45, v50, v51
    ds_write_b128 v224, v[40:43] offset:4096
    v_cvt_pk_bf16_f32 v46, v52, v53
    v_cvt_pk_bf16_f32 v47, v54, v55
    s_waitcnt lgkmcnt(5)
    v_mfma_f32_32x32x16_bf16 v[200:215], v[244:247], v[168:171], v[200:215]
    ds_read_b128 v[244:247], v1 offset:416
    v_cvt_pk_bf16_f32 v56, v56, v57
    v_cvt_pk_bf16_f32 v57, v58, v59
    ds_write_b128 v224, v[44:47] offset:5120
    v_mfma_f32_32x32x16_bf16 v[200:215], v[248:251], v[172:175], v[200:215]
    ds_read_b128 v[248:251], v1 offset:448
    v_cvt_pk_bf16_f32 v58, v60, v61
    v_cvt_pk_bf16_f32 v59, v62, v63
    v_cvt_pk_bf16_f32 v60, v64, v65
    v_cvt_pk_bf16_f32 v61, v66, v67
    v_mfma_f32_32x32x16_bf16 v[200:215], v[252:255], v[176:179], v[200:215]
    ds_read_b128 v[252:255], v1 offset:480
    ds_write_b128 v224, v[56:59] offset:6144
    v_cvt_pk_bf16_f32 v62, v68, v69
    v_cvt_pk_bf16_f32 v63, v70, v71
    ds_write_b128 v224, v[60:63] offset:7168
    s_waitcnt lgkmcnt(6)
    v_mfma_f32_32x32x16_bf16 v[200:215], v[232:235], v[180:183], v[200:215]
    s_mov_b32 s35, s33
    s_mov_b32 s36, s34
    s_mov_b32 s48, s49
    s_mov_b32 s41, 1
    v_mfma_f32_32x32x16_bf16 v[200:215], v[240:243], v[184:187], v[200:215]
    s_waitcnt lgkmcnt(0)
    s_barrier
    ds_read_b128 v[16:19], v225 offset:0
    ds_read_b128 v[20:23], v225 offset:1024
    v_mfma_f32_32x32x16_bf16 v[200:215], v[244:247], v[188:191], v[200:215]
    ds_read_b128 v[32:35], v225 offset:2048
    ds_read_b128 v[36:39], v225 offset:3072
    ds_read_b128 v[48:51], v225 offset:4096
    ds_read_b128 v[52:55], v225 offset:5120
    v_add_u32 v1, s38, v1
    s_sub_u32 s38, 0, s38
    v_mfma_f32_32x32x16_bf16 v[200:215], v[248:251], v[192:195], v[200:215]
    ds_read_b128 v[64:67], v225 offset:6144
    ds_read_b128 v[68:71], v225 offset:7168
    v_mov_b32 v8, v6
    v_mfma_f32_32x32x16_bf16 v[200:215], v[252:255], v[196:199], v[200:215]
    s_waitcnt lgkmcnt(6)
    v_mfma_f32_32x32x16_bf16 v[72:87], v[216:219], v[16:19], v[72:87]
    s_nop 4
    v_mfma_f32_32x32x16_bf16 v[72:87], v[220:223], v[20:23], v[72:87]
    s_nop 3
    s_waitcnt lgkmcnt(0)
    v_mfma_f32_32x32x16_bf16 v[88:103], v[216:219], v[32:35], v[88:103]
    v_max3_f32 v6, v200, v201, v202
    v_max3_f32 v6, v6, v203, v204
    v_max3_f32 v6, v6, v205, v206
    v_max3_f32 v6, v6, v207, v208
    v_max3_f32 v6, v6, v209, v210
    v_max3_f32 v6, v6, v211, v212
    v_max3_f32 v6, v6, v213, v214
    v_max_f32 v6, v6, v215
    v_mov_b32 v224, v6
    v_mfma_f32_32x32x16_bf16 v[88:103], v[220:223], v[36:39], v[88:103]
    v_mov_b32 v5, 0
    s_nop 0
    v_permlane32_swap_b32 v224, v6
    v_max_f32 v6, v6, v224
    v_mul_f32 v4, s48, v6
    v_rndne_f32 v4, v4
    v_mul_f32 v4, 0x41800000, v4
    v_fma_f32 v200, v200, s36, -v4
    v_fma_f32 v201, v201, s36, -v4
    v_fma_f32 v202, v202, s36, -v4
    v_mfma_f32_32x32x16_bf16 v[104:119], v[216:219], v[48:51], v[104:119]
    v_exp_f32 v200, v200
    v_fma_f32 v203, v203, s36, -v4
    v_exp_f32 v201, v201
    v_fma_f32 v204, v204, s36, -v4
    v_exp_f32 v202, v202
    v_add_f32 v5, v5, v200
    v_mfma_f32_32x32x16_bf16 v[104:119], v[220:223], v[52:55], v[104:119]
    v_fma_f32 v205, v205, s36, -v4
    v_exp_f32 v203, v203
    v_add_f32 v5, v5, v201
    v_fma_f32 v206, v206, s36, -v4
    v_exp_f32 v204, v204
    v_add_f32 v5, v5, v202
    v_fma_f32 v207, v207, s36, -v4
    v_mfma_f32_32x32x16_bf16 v[120:135], v[216:219], v[64:67], v[120:135]
    v_exp_f32 v205, v205
    v_add_f32 v5, v5, v203
    v_exp_f32 v206, v206
    v_add_f32 v5, v5, v204
    v_exp_f32 v207, v207
    v_add_f32 v5, v5, v205
    v_add_f32 v5, v5, v206
    v_mfma_f32_32x32x16_bf16 v[120:135], v[220:223], v[68:71], v[120:135]
    v_add_f32 v5, v5, v207
    v_fma_f32 v224, v208, s36, -v4
    v_fma_f32 v225, v209, s36, -v4
    v_fma_f32 v226, v210, s36, -v4
    v_fma_f32 v227, v211, s36, -v4
    v_fma_f32 v228, v212, s36, -v4
    v_fma_f32 v229, v213, s36, -v4
    v_fma_f32 v230, v214, s36, -v4
    v_fma_f32 v231, v215, s36, -v4
    v_cvt_pk_bf16_f32 v216, v200, v201
    v_cvt_pk_bf16_f32 v217, v202, v203
    v_cvt_pk_bf16_f32 v218, v204, v205
    v_cvt_pk_bf16_f32 v219, v206, v207
    v_pk_mul_f32 v[72:73], v[72:73], v[6:7] op_sel:[0,1] op_sel_hi:[1,1]
    v_pk_mul_f32 v[74:75], v[74:75], v[6:7] op_sel:[0,1] op_sel_hi:[1,1]
    v_pk_mul_f32 v[76:77], v[76:77], v[6:7] op_sel:[0,1] op_sel_hi:[1,1]
    v_pk_mul_f32 v[78:79], v[78:79], v[6:7] op_sel:[0,1] op_sel_hi:[1,1]
    v_pk_mul_f32 v[80:81], v[80:81], v[6:7] op_sel:[0,1] op_sel_hi:[1,1]
    v_pk_mul_f32 v[82:83], v[82:83], v[6:7] op_sel:[0,1] op_sel_hi:[1,1]
    v_pk_mul_f32 v[84:85], v[84:85], v[6:7] op_sel:[0,1] op_sel_hi:[1,1]
    v_pk_mul_f32 v[86:87], v[86:87], v[6:7] op_sel:[0,1] op_sel_hi:[1,1]
    v_cvt_pk_bf16_f32 v72, v72, v73
    v_cvt_pk_bf16_f32 v73, v74, v75
    v_cvt_pk_bf16_f32 v74, v76, v77
    v_cvt_pk_bf16_f32 v75, v78, v79
    v_cvt_pk_bf16_f32 v76, v80, v81
    v_cvt_pk_bf16_f32 v77, v82, v83
    v_cvt_pk_bf16_f32 v78, v84, v85
    v_cvt_pk_bf16_f32 v79, v86, v87
    s_mov_b64 vcc, s[56:57]
    v_cndmask_b32_dpp v80, v76, v72, vcc quad_perm:[1,0,3,2] row_mask:0xf bank_mask:0xf
    v_cndmask_b32_dpp v81, v77, v73, vcc quad_perm:[1,0,3,2] row_mask:0xf bank_mask:0xf
    v_cndmask_b32_dpp v82, v78, v74, vcc quad_perm:[1,0,3,2] row_mask:0xf bank_mask:0xf
    v_cndmask_b32_dpp v83, v79, v75, vcc quad_perm:[1,0,3,2] row_mask:0xf bank_mask:0xf
    s_not_b64 vcc, vcc
    v_cndmask_b32_dpp v84, v72, v76, vcc quad_perm:[1,0,3,2] row_mask:0xf bank_mask:0xf
    v_cndmask_b32_dpp v85, v73, v77, vcc quad_perm:[1,0,3,2] row_mask:0xf bank_mask:0xf
    v_cndmask_b32_dpp v86, v74, v78, vcc quad_perm:[1,0,3,2] row_mask:0xf bank_mask:0xf
    v_cndmask_b32_dpp v87, v75, v79, vcc quad_perm:[1,0,3,2] row_mask:0xf bank_mask:0xf
    v_pk_mul_f32 v[88:89], v[88:89], v[6:7] op_sel:[0,1] op_sel_hi:[1,1]
    v_pk_mul_f32 v[90:91], v[90:91], v[6:7] op_sel:[0,1] op_sel_hi:[1,1]
    v_pk_mul_f32 v[92:93], v[92:93], v[6:7] op_sel:[0,1] op_sel_hi:[1,1]
    v_pk_mul_f32 v[94:95], v[94:95], v[6:7] op_sel:[0,1] op_sel_hi:[1,1]
    v_pk_mul_f32 v[96:97], v[96:97], v[6:7] op_sel:[0,1] op_sel_hi:[1,1]
    v_pk_mul_f32 v[98:99], v[98:99], v[6:7] op_sel:[0,1] op_sel_hi:[1,1]
    v_pk_mul_f32 v[100:101], v[100:101], v[6:7] op_sel:[0,1] op_sel_hi:[1,1]
    v_pk_mul_f32 v[102:103], v[102:103], v[6:7] op_sel:[0,1] op_sel_hi:[1,1]
    v_cvt_pk_bf16_f32 v88, v88, v89
    v_cvt_pk_bf16_f32 v89, v90, v91
    v_cvt_pk_bf16_f32 v90, v92, v93
    v_cvt_pk_bf16_f32 v91, v94, v95
    v_cvt_pk_bf16_f32 v92, v96, v97
    v_cvt_pk_bf16_f32 v93, v98, v99
    v_cvt_pk_bf16_f32 v94, v100, v101
    v_cvt_pk_bf16_f32 v95, v102, v103
    s_mov_b64 vcc, s[56:57]
    v_cndmask_b32_dpp v96, v92, v88, vcc quad_perm:[1,0,3,2] row_mask:0xf bank_mask:0xf
    v_cndmask_b32_dpp v97, v93, v89, vcc quad_perm:[1,0,3,2] row_mask:0xf bank_mask:0xf
    v_cndmask_b32_dpp v98, v94, v90, vcc quad_perm:[1,0,3,2] row_mask:0xf bank_mask:0xf
    v_cndmask_b32_dpp v99, v95, v91, vcc quad_perm:[1,0,3,2] row_mask:0xf bank_mask:0xf
    s_not_b64 vcc, vcc
    v_cndmask_b32_dpp v100, v88, v92, vcc quad_perm:[1,0,3,2] row_mask:0xf bank_mask:0xf
    v_cndmask_b32_dpp v101, v89, v93, vcc quad_perm:[1,0,3,2] row_mask:0xf bank_mask:0xf
    v_cndmask_b32_dpp v102, v90, v94, vcc quad_perm:[1,0,3,2] row_mask:0xf bank_mask:0xf
    v_cndmask_b32_dpp v103, v91, v95, vcc quad_perm:[1,0,3,2] row_mask:0xf bank_mask:0xf
    v_pk_mul_f32 v[104:105], v[104:105], v[6:7] op_sel:[0,1] op_sel_hi:[1,1]
    v_pk_mul_f32 v[106:107], v[106:107], v[6:7] op_sel:[0,1] op_sel_hi:[1,1]
    v_pk_mul_f32 v[108:109], v[108:109], v[6:7] op_sel:[0,1] op_sel_hi:[1,1]
    v_pk_mul_f32 v[110:111], v[110:111], v[6:7] op_sel:[0,1] op_sel_hi:[1,1]
    v_pk_mul_f32 v[112:113], v[112:113], v[6:7] op_sel:[0,1] op_sel_hi:[1,1]
    v_pk_mul_f32 v[114:115], v[114:115], v[6:7] op_sel:[0,1] op_sel_hi:[1,1]
    v_pk_mul_f32 v[116:117], v[116:117], v[6:7] op_sel:[0,1] op_sel_hi:[1,1]
    v_pk_mul_f32 v[118:119], v[118:119], v[6:7] op_sel:[0,1] op_sel_hi:[1,1]
    v_cvt_pk_bf16_f32 v104, v104, v105
    v_cvt_pk_bf16_f32 v105, v106, v107
    v_cvt_pk_bf16_f32 v106, v108, v109
    v_cvt_pk_bf16_f32 v107, v110, v111
    v_cvt_pk_bf16_f32 v108, v112, v113
    v_cvt_pk_bf16_f32 v109, v114, v115
    v_cvt_pk_bf16_f32 v110, v116, v117
    v_cvt_pk_bf16_f32 v111, v118, v119
    s_mov_b64 vcc, s[56:57]
    v_cndmask_b32_dpp v112, v108, v104, vcc quad_perm:[1,0,3,2] row_mask:0xf bank_mask:0xf
    v_cndmask_b32_dpp v113, v109, v105, vcc quad_perm:[1,0,3,2] row_mask:0xf bank_mask:0xf
    v_cndmask_b32_dpp v114, v110, v106, vcc quad_perm:[1,0,3,2] row_mask:0xf bank_mask:0xf
    v_cndmask_b32_dpp v115, v111, v107, vcc quad_perm:[1,0,3,2] row_mask:0xf bank_mask:0xf
    s_not_b64 vcc, vcc
    v_cndmask_b32_dpp v116, v104, v108, vcc quad_perm:[1,0,3,2] row_mask:0xf bank_mask:0xf
    v_cndmask_b32_dpp v117, v105, v109, vcc quad_perm:[1,0,3,2] row_mask:0xf bank_mask:0xf
    v_cndmask_b32_dpp v118, v106, v110, vcc quad_perm:[1,0,3,2] row_mask:0xf bank_mask:0xf
    v_cndmask_b32_dpp v119, v107, v111, vcc quad_perm:[1,0,3,2] row_mask:0xf bank_mask:0xf
    v_pk_mul_f32 v[120:121], v[120:121], v[6:7] op_sel:[0,1] op_sel_hi:[1,1]
    v_pk_mul_f32 v[122:123], v[122:123], v[6:7] op_sel:[0,1] op_sel_hi:[1,1]
    v_pk_mul_f32 v[124:125], v[124:125], v[6:7] op_sel:[0,1] op_sel_hi:[1,1]
    v_pk_mul_f32 v[126:127], v[126:127], v[6:7] op_sel:[0,1] op_sel_hi:[1,1]
    v_pk_mul_f32 v[128:129], v[128:129], v[6:7] op_sel:[0,1] op_sel_hi:[1,1]
    v_pk_mul_f32 v[130:131], v[130:131], v[6:7] op_sel:[0,1] op_sel_hi:[1,1]
    v_pk_mul_f32 v[132:133], v[132:133], v[6:7] op_sel:[0,1] op_sel_hi:[1,1]
    v_pk_mul_f32 v[134:135], v[134:135], v[6:7] op_sel:[0,1] op_sel_hi:[1,1]
    v_cvt_pk_bf16_f32 v120, v120, v121
    v_cvt_pk_bf16_f32 v121, v122, v123
    v_cvt_pk_bf16_f32 v122, v124, v125
    v_cvt_pk_bf16_f32 v123, v126, v127
    v_cvt_pk_bf16_f32 v124, v128, v129
    v_cvt_pk_bf16_f32 v125, v130, v131
    v_cvt_pk_bf16_f32 v126, v132, v133
    v_cvt_pk_bf16_f32 v127, v134, v135
    s_mov_b64 vcc, s[56:57]
    v_cndmask_b32_dpp v128, v124, v120, vcc quad_perm:[1,0,3,2] row_mask:0xf bank_mask:0xf
    v_cndmask_b32_dpp v129, v125, v121, vcc quad_perm:[1,0,3,2] row_mask:0xf bank_mask:0xf
    v_cndmask_b32_dpp v130, v126, v122, vcc quad_perm:[1,0,3,2] row_mask:0xf bank_mask:0xf
    v_cndmask_b32_dpp v131, v127, v123, vcc quad_perm:[1,0,3,2] row_mask:0xf bank_mask:0xf
    s_not_b64 vcc, vcc
    v_cndmask_b32_dpp v132, v120, v124, vcc quad_perm:[1,0,3,2] row_mask:0xf bank_mask:0xf
    v_cndmask_b32_dpp v133, v121, v125, vcc quad_perm:[1,0,3,2] row_mask:0xf bank_mask:0xf
    v_cndmask_b32_dpp v134, v122, v126, vcc quad_perm:[1,0,3,2] row_mask:0xf bank_mask:0xf
    v_cndmask_b32_dpp v135, v123, v127, vcc quad_perm:[1,0,3,2] row_mask:0xf bank_mask:0xf
    s_mov_b64 vcc, s[58:59]
    s_add_u32 s53, s37, 4096
    v_cndmask_b32_dpp v16, v96, v80, vcc quad_perm:[2,3,0,1] row_mask:0xf bank_mask:0xf
    v_cndmask_b32_dpp v17, v97, v81, vcc quad_perm:[2,3,0,1] row_mask:0xf bank_mask:0xf
    v_cndmask_b32_dpp v18, v98, v82, vcc quad_perm:[2,3,0,1] row_mask:0xf bank_mask:0xf
    v_cndmask_b32_dpp v19, v99, v83, vcc quad_perm:[2,3,0,1] row_mask:0xf bank_mask:0xf
    v_cndmask_b32_dpp v48, v128, v112, vcc quad_perm:[2,3,0,1] row_mask:0xf bank_mask:0xf
    v_cndmask_b32_dpp v49, v129, v113, vcc quad_perm:[2,3,0,1] row_mask:0xf bank_mask:0xf
    v_cndmask_b32_dpp v50, v130, v114, vcc quad_perm:[2,3,0,1] row_mask:0xf bank_mask:0xf
    v_cndmask_b32_dpp v51, v131, v115, vcc quad_perm:[2,3,0,1] row_mask:0xf bank_mask:0xf
    s_mov_b32 vcc_lo, 0x0f0f0f0f
    s_mov_b32 vcc_hi, 0x0f0f0f0f
    v_cndmask_b32_dpp v12, v48, v16, vcc row_shr:4 row_mask:0xf bank_mask:0xf bound_ctrl:1
    v_cndmask_b32_dpp v13, v49, v17, vcc row_shr:4 row_mask:0xf bank_mask:0xf bound_ctrl:1
    v_cndmask_b32_dpp v14, v50, v18, vcc row_shr:4 row_mask:0xf bank_mask:0xf bound_ctrl:1
    v_cndmask_b32_dpp v15, v51, v19, vcc row_shr:4 row_mask:0xf bank_mask:0xf bound_ctrl:1
    buffer_store_dwordx4 v[12:15], v8, s[16:19], s37 offen offset:0 sc1
    v_mov_b32_dpp v48, v16 row_shl:4 row_mask:0xf bank_mask:0x5
    v_mov_b32_dpp v49, v17 row_shl:4 row_mask:0xf bank_mask:0x5
    v_mov_b32_dpp v50, v18 row_shl:4 row_mask:0xf bank_mask:0x5
    v_mov_b32_dpp v51, v19 row_shl:4 row_mask:0xf bank_mask:0x5
    buffer_store_dwordx4 v[48:51], v8, s[16:19], s53 offen offset:0 sc1
    s_mov_b64 vcc, s[58:59]
    v_cndmask_b32_dpp v20, v100, v84, vcc quad_perm:[2,3,0,1] row_mask:0xf bank_mask:0xf
    v_cndmask_b32_dpp v21, v101, v85, vcc quad_perm:[2,3,0,1] row_mask:0xf bank_mask:0xf
    v_cndmask_b32_dpp v22, v102, v86, vcc quad_perm:[2,3,0,1] row_mask:0xf bank_mask:0xf
    v_cndmask_b32_dpp v23, v103, v87, vcc quad_perm:[2,3,0,1] row_mask:0xf bank_mask:0xf
    v_cndmask_b32_dpp v52, v132, v116, vcc quad_perm:[2,3,0,1] row_mask:0xf bank_mask:0xf
    v_cndmask_b32_dpp v53, v133, v117, vcc quad_perm:[2,3,0,1] row_mask:0xf bank_mask:0xf
    v_cndmask_b32_dpp v54, v134, v118, vcc quad_perm:[2,3,0,1] row_mask:0xf bank_mask:0xf
    v_cndmask_b32_dpp v55, v135, v119, vcc quad_perm:[2,3,0,1] row_mask:0xf bank_mask:0xf
    s_mov_b32 vcc_lo, 0x0f0f0f0f
    s_mov_b32 vcc_hi, 0x0f0f0f0f
    v_cndmask_b32_dpp v28, v52, v20, vcc row_shr:4 row_mask:0xf bank_mask:0xf bound_ctrl:1
    v_cndmask_b32_dpp v29, v53, v21, vcc row_shr:4 row_mask:0xf bank_mask:0xf bound_ctrl:1
    v_cndmask_b32_dpp v30, v54, v22, vcc row_shr:4 row_mask:0xf bank_mask:0xf bound_ctrl:1
    v_cndmask_b32_dpp v31, v55, v23, vcc row_shr:4 row_mask:0xf bank_mask:0xf bound_ctrl:1
    buffer_store_dwordx4 v[28:31], v8, s[16:19], s37 offen offset:1024 sc1
    v_mov_b32_dpp v52, v20 row_shl:4 row_mask:0xf bank_mask:0x5
    v_mov_b32_dpp v53, v21 row_shl:4 row_mask:0xf bank_mask:0x5
    v_mov_b32_dpp v54, v22 row_shl:4 row_mask:0xf bank_mask:0x5
    v_mov_b32_dpp v55, v23 row_shl:4 row_mask:0xf bank_mask:0x5
    buffer_store_dwordx4 v[52:55], v8, s[16:19], s53 offen offset:1024 sc1
    s_mov_b64 vcc, s[58:59]
    s_not_b64 vcc, vcc
    v_cndmask_b32_dpp v32, v80, v96, vcc quad_perm:[2,3,0,1] row_mask:0xf bank_mask:0xf
    v_cndmask_b32_dpp v33, v81, v97, vcc quad_perm:[2,3,0,1] row_mask:0xf bank_mask:0xf
    v_cndmask_b32_dpp v34, v82, v98, vcc quad_perm:[2,3,0,1] row_mask:0xf bank_mask:0xf
    v_cndmask_b32_dpp v35, v83, v99, vcc quad_perm:[2,3,0,1] row_mask:0xf bank_mask:0xf
    v_cndmask_b32_dpp v64, v112, v128, vcc quad_perm:[2,3,0,1] row_mask:0xf bank_mask:0xf
    v_cndmask_b32_dpp v65, v113, v129, vcc quad_perm:[2,3,0,1] row_mask:0xf bank_mask:0xf
    v_cndmask_b32_dpp v66, v114, v130, vcc quad_perm:[2,3,0,1] row_mask:0xf bank_mask:0xf
    v_cndmask_b32_dpp v67, v115, v131, vcc quad_perm:[2,3,0,1] row_mask:0xf bank_mask:0xf
    s_mov_b32 vcc_lo, 0x0f0f0f0f
    s_mov_b32 vcc_hi, 0x0f0f0f0f
    v_cndmask_b32_dpp v44, v64, v32, vcc row_shr:4 row_mask:0xf bank_mask:0xf bound_ctrl:1
    v_cndmask_b32_dpp v45, v65, v33, vcc row_shr:4 row_mask:0xf bank_mask:0xf bound_ctrl:1
    v_cndmask_b32_dpp v46, v66, v34, vcc row_shr:4 row_mask:0xf bank_mask:0xf bound_ctrl:1
    v_cndmask_b32_dpp v47, v67, v35, vcc row_shr:4 row_mask:0xf bank_mask:0xf bound_ctrl:1
    buffer_store_dwordx4 v[44:47], v8, s[16:19], s37 offen offset:2048 sc1
    v_mov_b32_dpp v64, v32 row_shl:4 row_mask:0xf bank_mask:0x5
    v_mov_b32_dpp v65, v33 row_shl:4 row_mask:0xf bank_mask:0x5
    v_mov_b32_dpp v66, v34 row_shl:4 row_mask:0xf bank_mask:0x5
    v_mov_b32_dpp v67, v35 row_shl:4 row_mask:0xf bank_mask:0x5
    buffer_store_dwordx4 v[64:67], v8, s[16:19], s53 offen offset:2048 sc1
    s_not_b64 vcc, s[58:59]
    v_cndmask_b32_dpp v36, v84, v100, vcc quad_perm:[2,3,0,1] row_mask:0xf bank_mask:0xf
    v_cndmask_b32_dpp v37, v85, v101, vcc quad_perm:[2,3,0,1] row_mask:0xf bank_mask:0xf
    v_cndmask_b32_dpp v38, v86, v102, vcc quad_perm:[2,3,0,1] row_mask:0xf bank_mask:0xf
    v_cndmask_b32_dpp v39, v87, v103, vcc quad_perm:[2,3,0,1] row_mask:0xf bank_mask:0xf
    v_cndmask_b32_dpp v68, v116, v132, vcc quad_perm:[2,3,0,1] row_mask:0xf bank_mask:0xf
    v_cndmask_b32_dpp v69, v117, v133, vcc quad_perm:[2,3,0,1] row_mask:0xf bank_mask:0xf
    v_cndmask_b32_dpp v70, v118, v134, vcc quad_perm:[2,3,0,1] row_mask:0xf bank_mask:0xf
    v_cndmask_b32_dpp v71, v119, v135, vcc quad_perm:[2,3,0,1] row_mask:0xf bank_mask:0xf
    s_mov_b32 vcc_lo, 0x0f0f0f0f
    s_mov_b32 vcc_hi, 0x0f0f0f0f
    v_cndmask_b32_dpp v60, v68, v36, vcc row_shr:4 row_mask:0xf bank_mask:0xf bound_ctrl:1
    v_cndmask_b32_dpp v61, v69, v37, vcc row_shr:4 row_mask:0xf bank_mask:0xf bound_ctrl:1
    v_cndmask_b32_dpp v62, v70, v38, vcc row_shr:4 row_mask:0xf bank_mask:0xf bound_ctrl:1
    v_cndmask_b32_dpp v63, v71, v39, vcc row_shr:4 row_mask:0xf bank_mask:0xf bound_ctrl:1
    buffer_store_dwordx4 v[60:63], v8, s[16:19], s37 offen offset:3072 sc1
    v_mov_b32_dpp v68, v36 row_shl:4 row_mask:0xf bank_mask:0x5
    v_mov_b32_dpp v69, v37 row_shl:4 row_mask:0xf bank_mask:0x5
    v_mov_b32_dpp v70, v38 row_shl:4 row_mask:0xf bank_mask:0x5
    v_mov_b32_dpp v71, v39 row_shl:4 row_mask:0xf bank_mask:0x5
    buffer_store_dwordx4 v[68:71], v8, s[16:19], s53 offen offset:3072 sc1
    s_lshl_b32 s37, s30, 15
    s_add_u32 s37, s37, s31
    s_waitcnt lgkmcnt(0)
    s_barrier
    s_branch L_item
L_fin:
    v_mfma_f32_32x32x16_bf16 v[88:103], v[244:247], v[220:223], v[88:103]
    v_and_b32 v6, 24, v229
    v_lshrrev_b32 v231, 5, v229
    v_lshl_add_u32 v6, v6, 10, s46
    v_mfma_f32_32x32x16_bf16 v[104:119], v[248:251], v[220:223], v[104:119]
    v_lshl_add_u32 v6, v231, 7, v6
    v_and_b32 v231, 7, v229
    v_lshl_add_u32 v6, v231, 4, v6
    v_mfma_f32_32x32x16_bf16 v[120:135], v[252:255], v[220:223], v[120:135]
    ds_read_b128 v[216:219], v226 offset:0
    ds_read_b128 v[220:223], v226 offset:1024
    s_cbranch_vccnz L_rare_xf
L_ret_xf:
    v_cvt_pk_bf16_f32 v8, v8, v9
    v_cvt_pk_bf16_f32 v9, v10, v11
    v_cvt_pk_bf16_f32 v10, v12, v13
    v_cvt_pk_bf16_f32 v11, v14, v15
    v_cvt_pk_bf16_f32 v12, v16, v17
    v_cvt_pk_bf16_f32 v13, v18, v19
    ds_write_b128 v224, v[8:11] offset:0
    v_cvt_pk_bf16_f32 v14, v20, v21
    v_cvt_pk_bf16_f32 v15, v22, v23
    v_cvt_pk_bf16_f32 v24, v24, v25
    v_cvt_pk_bf16_f32 v25, v26, v27
    ds_write_b128 v224, v[12:15] offset:1024
    v_cvt_pk_bf16_f32 v26, v28, v29
    v_cvt_pk_bf16_f32 v27, v30, v31
    v_cvt_pk_bf16_f32 v28, v32, v33
    v_cvt_pk_bf16_f32 v29, v34, v35
    ds_write_b128 v224, v[24:27] offset:2048
    v_cvt_pk_bf16_f32 v30, v36, v37
    v_cvt_pk_bf16_f32 v31, v38, v39
    v_cvt_pk_bf16_f32 v40, v40, v41
    v_cvt_pk_bf16_f32 v41, v42, v43
    ds_write_b128 v224, v[28:31] offset:3072
    v_cvt_pk_bf16_f32 v42, v44, v45
    v_cvt_pk_bf16_f32 v43, v46, v47
    v_cvt_pk_bf16_f32 v44, v48, v49
    v_cvt_pk_bf16_f32 v45, v50, v51
    ds_write_b128 v224, v[40:43] offset:4096
    v_cvt_pk_bf16_f32 v46, v52, v53
    v_cvt_pk_bf16_f32 v47, v54, v55
    v_cvt_pk_bf16_f32 v56, v56, v57
    v_cvt_pk_bf16_f32 v57, v58, v59
    ds_write_b128 v224, v[44:47] offset:5120
    v_cvt_pk_bf16_f32 v58, v60, v61
    v_cvt_pk_bf16_f32 v59, v62, v63
    v_cvt_pk_bf16_f32 v60, v64, v65
    v_cvt_pk_bf16_f32 v61, v66, v67
    ds_write_b128 v224, v[56:59] offset:6144
    v_cvt_pk_bf16_f32 v62, v68, v69
    v_cvt_pk_bf16_f32 v63, v70, v71
    ds_write_b128 v224, v[60:63] offset:7168
    s_waitcnt lgkmcnt(0)
    s_barrier
    ds_read_b128 v[16:19], v225 offset:0
    ds_read_b128 v[20:23], v225 offset:1024
    ds_read_b128 v[32:35], v225 offset:2048
    ds_read_b128 v[36:39], v225 offset:3072
    ds_read_b128 v[48:51], v225 offset:4096
    ds_read_b128 v[52:55], v225 offset:5120
    ds_read_b128 v[64:67], v225 offset:6144
    ds_read_b128 v[68:71], v225 offset:7168
    s_waitcnt lgkmcnt(7)
    v_mfma_f32_32x32x16_bf16 v[72:87], v[216:219], v[16:19], v[72:87]
    s_waitcnt lgkmcnt(6)
    v_mfma_f32_32x32x16_bf16 v[72:87], v[220:223], v[20:23], v[72:87]
    s_waitcnt lgkmcnt(5)
    v_mfma_f32_32x32x16_bf16 v[88:103], v[216:219], v[32:35], v[88:103]
    s_nop 7
    s_waitcnt lgkmcnt(0)
    v_mfma_f32_32x32x16_bf16 v[88:103], v[220:223], v[36:39], v[88:103]
    v_mfma_f32_32x32x16_bf16 v[104:119], v[216:219], v[48:51], v[104:119]
    v_mul_f32 v72, v72, v7
    v_mul_f32 v73, v73, v7
    v_mul_f32 v74, v74, v7
    v_mul_f32 v75, v75, v7
    v_mul_f32 v76, v76, v7
    v_mul_f32 v77, v77, v7
    v_mfma_f32_32x32x16_bf16 v[104:119], v[220:223], v[52:55], v[104:119]
    v_mul_f32 v78, v78, v7
    v_mul_f32 v79, v79, v7
    v_mul_f32 v80, v80, v7
    v_mul_f32 v81, v81, v7
    v_mul_f32 v82, v82, v7
    v_mul_f32 v83, v83, v7
    v_mfma_f32_32x32x16_bf16 v[120:135], v[216:219], v[64:67], v[120:135]
    v_mul_f32 v84, v84, v7
    v_mul_f32 v85, v85, v7
    v_mul_f32 v86, v86, v7
    v_mul_f32 v87, v87, v7
    v_cvt_pk_bf16_f32 v72, v72, v73
    v_cvt_pk_bf16_f32 v73, v74, v75
    v_mfma_f32_32x32x16_bf16 v[120:135], v[220:223], v[68:71], v[120:135]
    v_cvt_pk_bf16_f32 v74, v76, v77
    v_cvt_pk_bf16_f32 v75, v78, v79
    v_cvt_pk_bf16_f32 v76, v80, v81
    v_cvt_pk_bf16_f32 v77, v82, v83
    v_cvt_pk_bf16_f32 v78, v84, v85
    v_cvt_pk_bf16_f32 v79, v86, v87
    s_mov_b64 vcc, s[56:57]
    v_cndmask_b32_dpp v80, v76, v72, vcc quad_perm:[1,0,3,2] row_mask:0xf bank_mask:0xf
    v_cndmask_b32_dpp v81, v77, v73, vcc quad_perm:[1,0,3,2] row_mask:0xf bank_mask:0xf
    v_cndmask_b32_dpp v82, v78, v74, vcc quad_perm:[1,0,3,2] row_mask:0xf bank_mask:0xf
    v_cndmask_b32_dpp v83, v79, v75, vcc quad_perm:[1,0,3,2] row_mask:0xf bank_mask:0xf
    s_not_b64 vcc, vcc
    v_cndmask_b32_dpp v84, v72, v76, vcc quad_perm:[1,0,3,2] row_mask:0xf bank_mask:0xf
    v_cndmask_b32_dpp v85, v73, v77, vcc quad_perm:[1,0,3,2] row_mask:0xf bank_mask:0xf
    v_cndmask_b32_dpp v86, v74, v78, vcc quad_perm:[1,0,3,2] row_mask:0xf bank_mask:0xf
    v_cndmask_b32_dpp v87, v75, v79, vcc quad_perm:[1,0,3,2] row_mask:0xf bank_mask:0xf
    v_pk_mul_f32 v[88:89], v[88:89], v[6:7] op_sel:[0,1] op_sel_hi:[1,1]
    v_pk_mul_f32 v[90:91], v[90:91], v[6:7] op_sel:[0,1] op_sel_hi:[1,1]
    v_pk_mul_f32 v[92:93], v[92:93], v[6:7] op_sel:[0,1] op_sel_hi:[1,1]
    v_pk_mul_f32 v[94:95], v[94:95], v[6:7] op_sel:[0,1] op_sel_hi:[1,1]
    v_pk_mul_f32 v[96:97], v[96:97], v[6:7] op_sel:[0,1] op_sel_hi:[1,1]
    v_pk_mul_f32 v[98:99], v[98:99], v[6:7] op_sel:[0,1] op_sel_hi:[1,1]
    v_pk_mul_f32 v[100:101], v[100:101], v[6:7] op_sel:[0,1] op_sel_hi:[1,1]
    v_pk_mul_f32 v[102:103], v[102:103], v[6:7] op_sel:[0,1] op_sel_hi:[1,1]
    v_cvt_pk_bf16_f32 v88, v88, v89
    v_cvt_pk_bf16_f32 v89, v90, v91
    v_cvt_pk_bf16_f32 v90, v92, v93
    v_cvt_pk_bf16_f32 v91, v94, v95
    v_cvt_pk_bf16_f32 v92, v96, v97
    v_cvt_pk_bf16_f32 v93, v98, v99
    v_cvt_pk_bf16_f32 v94, v100, v101
    v_cvt_pk_bf16_f32 v95, v102, v103
    s_mov_b64 vcc, s[56:57]
    v_cndmask_b32_dpp v96, v92, v88, vcc quad_perm:[1,0,3,2] row_mask:0xf bank_mask:0xf
    v_cndmask_b32_dpp v97, v93, v89, vcc quad_perm:[1,0,3,2] row_mask:0xf bank_mask:0xf
    v_cndmask_b32_dpp v98, v94, v90, vcc quad_perm:[1,0,3,2] row_mask:0xf bank_mask:0xf
    v_cndmask_b32_dpp v99, v95, v91, vcc quad_perm:[1,0,3,2] row_mask:0xf bank_mask:0xf
    s_not_b64 vcc, vcc
    v_cndmask_b32_dpp v100, v88, v92, vcc quad_perm:[1,0,3,2] row_mask:0xf bank_mask:0xf
    v_cndmask_b32_dpp v101, v89, v93, vcc quad_perm:[1,0,3,2] row_mask:0xf bank_mask:0xf
    v_cndmask_b32_dpp v102, v90, v94, vcc quad_perm:[1,0,3,2] row_mask:0xf bank_mask:0xf
    v_cndmask_b32_dpp v103, v91, v95, vcc quad_perm:[1,0,3,2] row_mask:0xf bank_mask:0xf
    v_pk_mul_f32 v[104:105], v[104:105], v[6:7] op_sel:[0,1] op_sel_hi:[1,1]
    v_pk_mul_f32 v[106:107], v[106:107], v[6:7] op_sel:[0,1] op_sel_hi:[1,1]
    v_pk_mul_f32 v[108:109], v[108:109], v[6:7] op_sel:[0,1] op_sel_hi:[1,1]
    v_pk_mul_f32 v[110:111], v[110:111], v[6:7] op_sel:[0,1] op_sel_hi:[1,1]
    v_pk_mul_f32 v[112:113], v[112:113], v[6:7] op_sel:[0,1] op_sel_hi:[1,1]
    v_pk_mul_f32 v[114:115], v[114:115], v[6:7] op_sel:[0,1] op_sel_hi:[1,1]
    v_pk_mul_f32 v[116:117], v[116:117], v[6:7] op_sel:[0,1] op_sel_hi:[1,1]
    v_pk_mul_f32 v[118:119], v[118:119], v[6:7] op_sel:[0,1] op_sel_hi:[1,1]
    v_cvt_pk_bf16_f32 v104, v104, v105
    v_cvt_pk_bf16_f32 v105, v106, v107
    v_cvt_pk_bf16_f32 v106, v108, v109
    v_cvt_pk_bf16_f32 v107, v110, v111
    v_cvt_pk_bf16_f32 v108, v112, v113
    v_cvt_pk_bf16_f32 v109, v114, v115
    v_cvt_pk_bf16_f32 v110, v116, v117
    v_cvt_pk_bf16_f32 v111, v118, v119
    s_mov_b64 vcc, s[56:57]
    v_cndmask_b32_dpp v112, v108, v104, vcc quad_perm:[1,0,3,2] row_mask:0xf bank_mask:0xf
    v_cndmask_b32_dpp v113, v109, v105, vcc quad_perm:[1,0,3,2] row_mask:0xf bank_mask:0xf
    v_cndmask_b32_dpp v114, v110, v106, vcc quad_perm:[1,0,3,2] row_mask:0xf bank_mask:0xf
    v_cndmask_b32_dpp v115, v111, v107, vcc quad_perm:[1,0,3,2] row_mask:0xf bank_mask:0xf
    s_not_b64 vcc, vcc
    v_cndmask_b32_dpp v116, v104, v108, vcc quad_perm:[1,0,3,2] row_mask:0xf bank_mask:0xf
    v_cndmask_b32_dpp v117, v105, v109, vcc quad_perm:[1,0,3,2] row_mask:0xf bank_mask:0xf
    v_cndmask_b32_dpp v118, v106, v110, vcc quad_perm:[1,0,3,2] row_mask:0xf bank_mask:0xf
    v_cndmask_b32_dpp v119, v107, v111, vcc quad_perm:[1,0,3,2] row_mask:0xf bank_mask:0xf
    v_pk_mul_f32 v[120:121], v[120:121], v[6:7] op_sel:[0,1] op_sel_hi:[1,1]
    v_pk_mul_f32 v[122:123], v[122:123], v[6:7] op_sel:[0,1] op_sel_hi:[1,1]
    v_pk_mul_f32 v[124:125], v[124:125], v[6:7] op_sel:[0,1] op_sel_hi:[1,1]
    v_pk_mul_f32 v[126:127], v[126:127], v[6:7] op_sel:[0,1] op_sel_hi:[1,1]
    v_pk_mul_f32 v[128:129], v[128:129], v[6:7] op_sel:[0,1] op_sel_hi:[1,1]
    v_pk_mul_f32 v[130:131], v[130:131], v[6:7] op_sel:[0,1] op_sel_hi:[1,1]
    v_pk_mul_f32 v[132:133], v[132:133], v[6:7] op_sel:[0,1] op_sel_hi:[1,1]
    v_pk_mul_f32 v[134:135], v[134:135], v[6:7] op_sel:[0,1] op_sel_hi:[1,1]
    v_cvt_pk_bf16_f32 v120, v120, v121
    v_cvt_pk_bf16_f32 v121, v122, v123
    v_cvt_pk_bf16_f32 v122, v124, v125
    v_cvt_pk_bf16_f32 v123, v126, v127
    v_cvt_pk_bf16_f32 v124, v128, v129
    v_cvt_pk_bf16_f32 v125, v130, v131
    v_cvt_pk_bf16_f32 v126, v132, v133
    v_cvt_pk_bf16_f32 v127, v134, v135
    s_mov_b64 vcc, s[56:57]
    v_cndmask_b32_dpp v128, v124, v120, vcc quad_perm:[1,0,3,2] row_mask:0xf bank_mask:0xf
    v_cndmask_b32_dpp v129, v125, v121, vcc quad_perm:[1,0,3,2] row_mask:0xf bank_mask:0xf
    v_cndmask_b32_dpp v130, v126, v122, vcc quad_perm:[1,0,3,2] row_mask:0xf bank_mask:0xf
    v_cndmask_b32_dpp v131, v127, v123, vcc quad_perm:[1,0,3,2] row_mask:0xf bank_mask:0xf
    s_not_b64 vcc, vcc
    v_cndmask_b32_dpp v132, v120, v124, vcc quad_perm:[1,0,3,2] row_mask:0xf bank_mask:0xf
    v_cndmask_b32_dpp v133, v121, v125, vcc quad_perm:[1,0,3,2] row_mask:0xf bank_mask:0xf
    v_cndmask_b32_dpp v134, v122, v126, vcc quad_perm:[1,0,3,2] row_mask:0xf bank_mask:0xf
    v_cndmask_b32_dpp v135, v123, v127, vcc quad_perm:[1,0,3,2] row_mask:0xf bank_mask:0xf
    s_mov_b64 vcc, s[58:59]
    s_add_u32 s53, s37, 4096
    v_cndmask_b32_dpp v16, v96, v80, vcc quad_perm:[2,3,0,1] row_mask:0xf bank_mask:0xf
    v_cndmask_b32_dpp v17, v97, v81, vcc quad_perm:[2,3,0,1] row_mask:0xf bank_mask:0xf
    v_cndmask_b32_dpp v18, v98, v82, vcc quad_perm:[2,3,0,1] row_mask:0xf bank_mask:0xf
    v_cndmask_b32_dpp v19, v99, v83, vcc quad_perm:[2,3,0,1] row_mask:0xf bank_mask:0xf
    v_cndmask_b32_dpp v48, v128, v112, vcc quad_perm:[2,3,0,1] row_mask:0xf bank_mask:0xf
    v_cndmask_b32_dpp v49, v129, v113, vcc quad_perm:[2,3,0,1] row_mask:0xf bank_mask:0xf
    v_cndmask_b32_dpp v50, v130, v114, vcc quad_perm:[2,3,0,1] row_mask:0xf bank_mask:0xf
    v_cndmask_b32_dpp v51, v131, v115, vcc quad_perm:[2,3,0,1] row_mask:0xf bank_mask:0xf
    s_mov_b32 vcc_lo, 0x0f0f0f0f
    s_mov_b32 vcc_hi, 0x0f0f0f0f
    v_cndmask_b32_dpp v12, v48, v16, vcc row_shr:4 row_mask:0xf bank_mask:0xf bound_ctrl:1
    v_cndmask_b32_dpp v13, v49, v17, vcc row_shr:4 row_mask:0xf bank_mask:0xf bound_ctrl:1
    v_cndmask_b32_dpp v14, v50, v18, vcc row_shr:4 row_mask:0xf bank_mask:0xf bound_ctrl:1
    v_cndmask_b32_dpp v15, v51, v19, vcc row_shr:4 row_mask:0xf bank_mask:0xf bound_ctrl:1
    buffer_store_dwordx4 v[12:15], v6, s[16:19], s37 offen offset:0 sc1
    v_mov_b32_dpp v48, v16 row_shl:4 row_mask:0xf bank_mask:0x5
    v_mov_b32_dpp v49, v17 row_shl:4 row_mask:0xf bank_mask:0x5
    v_mov_b32_dpp v50, v18 row_shl:4 row_mask:0xf bank_mask:0x5
    v_mov_b32_dpp v51, v19 row_shl:4 row_mask:0xf bank_mask:0x5
    buffer_store_dwordx4 v[48:51], v6, s[16:19], s53 offen offset:0 sc1
    s_mov_b64 vcc, s[58:59]
    v_cndmask_b32_dpp v20, v100, v84, vcc quad_perm:[2,3,0,1] row_mask:0xf bank_mask:0xf
    v_cndmask_b32_dpp v21, v101, v85, vcc quad_perm:[2,3,0,1] row_mask:0xf bank_mask:0xf
    v_cndmask_b32_dpp v22, v102, v86, vcc quad_perm:[2,3,0,1] row_mask:0xf bank_mask:0xf
    v_cndmask_b32_dpp v23, v103, v87, vcc quad_perm:[2,3,0,1] row_mask:0xf bank_mask:0xf
    v_cndmask_b32_dpp v52, v132, v116, vcc quad_perm:[2,3,0,1] row_mask:0xf bank_mask:0xf
    v_cndmask_b32_dpp v53, v133, v117, vcc quad_perm:[2,3,0,1] row_mask:0xf bank_mask:0xf
    v_cndmask_b32_dpp v54, v134, v118, vcc quad_perm:[2,3,0,1] row_mask:0xf bank_mask:0xf
    v_cndmask_b32_dpp v55, v135, v119, vcc quad_perm:[2,3,0,1] row_mask:0xf bank_mask:0xf
    s_mov_b32 vcc_lo, 0x0f0f0f0f
    s_mov_b32 vcc_hi, 0x0f0f0f0f
    v_cndmask_b32_dpp v28, v52, v20, vcc row_shr:4 row_mask:0xf bank_mask:0xf bound_ctrl:1
    v_cndmask_b32_dpp v29, v53, v21, vcc row_shr:4 row_mask:0xf bank_mask:0xf bound_ctrl:1
    v_cndmask_b32_dpp v30, v54, v22, vcc row_shr:4 row_mask:0xf bank_mask:0xf bound_ctrl:1
    v_cndmask_b32_dpp v31, v55, v23, vcc row_shr:4 row_mask:0xf bank_mask:0xf bound_ctrl:1
    buffer_store_dwordx4 v[28:31], v6, s[16:19], s37 offen offset:1024 sc1
    v_mov_b32_dpp v52, v20 row_shl:4 row_mask:0xf bank_mask:0x5
    v_mov_b32_dpp v53, v21 row_shl:4 row_mask:0xf bank_mask:0x5
    v_mov_b32_dpp v54, v22 row_shl:4 row_mask:0xf bank_mask:0x5
    v_mov_b32_dpp v55, v23 row_shl:4 row_mask:0xf bank_mask:0x5
    buffer_store_dwordx4 v[52:55], v6, s[16:19], s53 offen offset:1024 sc1
    s_mov_b64 vcc, s[58:59]
    s_not_b64 vcc, vcc
    v_cndmask_b32_dpp v32, v80, v96, vcc quad_perm:[2,3,0,1] row_mask:0xf bank_mask:0xf
    v_cndmask_b32_dpp v33, v81, v97, vcc quad_perm:[2,3,0,1] row_mask:0xf bank_mask:0xf
    v_cndmask_b32_dpp v34, v82, v98, vcc quad_perm:[2,3,0,1] row_mask:0xf bank_mask:0xf
    v_cndmask_b32_dpp v35, v83, v99, vcc quad_perm:[2,3,0,1] row_mask:0xf bank_mask:0xf
    v_cndmask_b32_dpp v64, v112, v128, vcc quad_perm:[2,3,0,1] row_mask:0xf bank_mask:0xf
    v_cndmask_b32_dpp v65, v113, v129, vcc quad_perm:[2,3,0,1] row_mask:0xf bank_mask:0xf
    v_cndmask_b32_dpp v66, v114, v130, vcc quad_perm:[2,3,0,1] row_mask:0xf bank_mask:0xf
    v_cndmask_b32_dpp v67, v115, v131, vcc quad_perm:[2,3,0,1] row_mask:0xf bank_mask:0xf
    s_mov_b32 vcc_lo, 0x0f0f0f0f
    s_mov_b32 vcc_hi, 0x0f0f0f0f
    v_cndmask_b32_dpp v44, v64, v32, vcc row_shr:4 row_mask:0xf bank_mask:0xf bound_ctrl:1
    v_cndmask_b32_dpp v45, v65, v33, vcc row_shr:4 row_mask:0xf bank_mask:0xf bound_ctrl:1
    v_cndmask_b32_dpp v46, v66, v34, vcc row_shr:4 row_mask:0xf bank_mask:0xf bound_ctrl:1
    v_cndmask_b32_dpp v47, v67, v35, vcc row_shr:4 row_mask:0xf bank_mask:0xf bound_ctrl:1
    buffer_store_dwordx4 v[44:47], v6, s[16:19], s37 offen offset:2048 sc1
    v_mov_b32_dpp v64, v32 row_shl:4 row_mask:0xf bank_mask:0x5
    v_mov_b32_dpp v65, v33 row_shl:4 row_mask:0xf bank_mask:0x5
    v_mov_b32_dpp v66, v34 row_shl:4 row_mask:0xf bank_mask:0x5
    v_mov_b32_dpp v67, v35 row_shl:4 row_mask:0xf bank_mask:0x5
    buffer_store_dwordx4 v[64:67], v6, s[16:19], s53 offen offset:2048 sc1
    s_not_b64 vcc, s[58:59]
    v_cndmask_b32_dpp v36, v84, v100, vcc quad_perm:[2,3,0,1] row_mask:0xf bank_mask:0xf
    v_cndmask_b32_dpp v37, v85, v101, vcc quad_perm:[2,3,0,1] row_mask:0xf bank_mask:0xf
    v_cndmask_b32_dpp v38, v86, v102, vcc quad_perm:[2,3,0,1] row_mask:0xf bank_mask:0xf
    v_cndmask_b32_dpp v39, v87, v103, vcc quad_perm:[2,3,0,1] row_mask:0xf bank_mask:0xf
    v_cndmask_b32_dpp v68, v116, v132, vcc quad_perm:[2,3,0,1] row_mask:0xf bank_mask:0xf
    v_cndmask_b32_dpp v69, v117, v133, vcc quad_perm:[2,3,0,1] row_mask:0xf bank_mask:0xf
    v_cndmask_b32_dpp v70, v118, v134, vcc quad_perm:[2,3,0,1] row_mask:0xf bank_mask:0xf
    v_cndmask_b32_dpp v71, v119, v135, vcc quad_perm:[2,3,0,1] row_mask:0xf bank_mask:0xf
    s_mov_b32 vcc_lo, 0x0f0f0f0f
    s_mov_b32 vcc_hi, 0x0f0f0f0f
    v_cndmask_b32_dpp v60, v68, v36, vcc row_shr:4 row_mask:0xf bank_mask:0xf bound_ctrl:1
    v_cndmask_b32_dpp v61, v69, v37, vcc row_shr:4 row_mask:0xf bank_mask:0xf bound_ctrl:1
    v_cndmask_b32_dpp v62, v70, v38, vcc row_shr:4 row_mask:0xf bank_mask:0xf bound_ctrl:1
    v_cndmask_b32_dpp v63, v71, v39, vcc row_shr:4 row_mask:0xf bank_mask:0xf bound_ctrl:1
    buffer_store_dwordx4 v[60:63], v6, s[16:19], s37 offen offset:3072 sc1
    v_mov_b32_dpp v68, v36 row_shl:4 row_mask:0xf bank_mask:0x5
    v_mov_b32_dpp v69, v37 row_shl:4 row_mask:0xf bank_mask:0x5
    v_mov_b32_dpp v70, v38 row_shl:4 row_mask:0xf bank_mask:0x5
    v_mov_b32_dpp v71, v39 row_shl:4 row_mask:0xf bank_mask:0x5
    buffer_store_dwordx4 v[68:71], v6, s[16:19], s53 offen offset:3072 sc1
L_out:
L_end:
    s_endpgm
L_zd:
    v_add_u32 v2, s39, v2
    v_add_u32 v3, s39, v3
    ds_read_b64_tr_b16 v[136:137], v2 offset:0
    ds_read_b64_tr_b16 v[138:139], v2 offset:8448
    ds_read_b64_tr_b16 v[140:141], v2 offset:32
    ds_read_b64_tr_b16 v[142:143], v2 offset:8480
    v_mfma_f32_32x32x16_bf16 v[88:103], v[244:247], v[220:223], v[88:103]
    ds_read_b64_tr_b16 v[144:145], v2 offset:64
    ds_read_b64_tr_b16 v[146:147], v2 offset:8512
    ds_read_b64_tr_b16 v[148:149], v2 offset:96
    ds_read_b64_tr_b16 v[150:151], v2 offset:8544
    v_cvt_pk_bf16_f32 v216, v200, v201
    v_cvt_pk_bf16_f32 v217, v202, v203
    v_cvt_pk_bf16_f32 v218, v204, v205
    v_cvt_pk_bf16_f32 v219, v206, v207
    v_mfma_f32_32x32x16_bf16 v[104:119], v[248:251], v[220:223], v[104:119]
    ds_read_b64_tr_b16 v[152:153], v3 offset:0
    ds_read_b64_tr_b16 v[154:155], v3 offset:8448
    ds_read_b64_tr_b16 v[156:157], v3 offset:32
    ds_read_b64_tr_b16 v[158:159], v3 offset:8480
    v_fma_f32 v224, v208, s36, -v4
    v_fma_f32 v225, v209, s36, -v4
    v_fma_f32 v226, v210, s36, -v4
    v_fma_f32 v227, v211, s36, -v4
    v_mfma_f32_32x32x16_bf16 v[120:135], v[252:255], v[220:223], v[120:135]
    ds_read_b64_tr_b16 v[168:169], v2 offset:16896
    ds_read_b64_tr_b16 v[170:171], v2 offset:25344
    ds_read_b64_tr_b16 v[172:173], v2 offset:16928
    s_waitcnt lgkmcnt(11)
    ds_read_b64_tr_b16 v[174:175], v2 offset:25376
    v_fma_f32 v228, v212, s36, -v4
    v_fma_f32 v229, v213, s36, -v4
    v_fma_f32 v230, v214, s36, -v4
    v_fma_f32 v231, v215, s36, -v4
    s_cbranch_vccnz L_rare_zd
L_ret_zd:
    v_mfma_f32_32x32x16_bf16 v[8:23], v[136:139], v[216:219], v[8:23]
    ds_read_b64_tr_b16 v[176:177], v2 offset:16960
    ds_read_b64_tr_b16 v[178:179], v2 offset:25408
    ds_read_b64_tr_b16 v[180:181], v2 offset:16992
    v_exp_f32 v224, v224
    v_exp_f32 v225, v225
    v_exp_f32 v226, v226
    v_mfma_f32_32x32x16_bf16 v[24:39], v[140:143], v[216:219], v[24:39]
    s_waitcnt lgkmcnt(7)
    ds_read_b64_tr_b16 v[182:183], v2 offset:25440
    ds_read_b64_tr_b16 v[160:161], v3 offset:64
    v_add_f32 v5, v5, v224
    v_exp_f32 v227, v227
    v_add_f32 v5, v5, v225
    v_exp_f32 v228, v228
    v_mfma_f32_32x32x16_bf16 v[40:55], v[144:147], v[216:219], v[40:55]
    ds_read_b64_tr_b16 v[162:163], v3 offset:8512
    ds_read_b64_tr_b16 v[164:165], v3 offset:96
    ds_read_b64_tr_b16 v[166:167], v3 offset:8544
    v_add_f32 v5, v5, v226
    v_exp_f32 v229, v229
    v_add_f32 v5, v5, v227
    v_mfma_f32_32x32x16_bf16 v[56:71], v[148:151], v[216:219], v[56:71]
    ds_read_b64_tr_b16 v[184:185], v3 offset:16896
    ds_read_b64_tr_b16 v[186:187], v3 offset:25344
    ds_read_b64_tr_b16 v[188:189], v3 offset:16928
    v_exp_f32 v230, v230
    v_add_f32 v5, v5, v228
    v_exp_f32 v231, v231
    v_add_f32 v5, v5, v229
    v_mfma_f32_32x32x16_bf16 v[72:87], v[152:155], v[216:219], v[72:87]
    s_waitcnt lgkmcnt(6)
    ds_read_b64_tr_b16 v[190:191], v3 offset:25376
    ds_read_b64_tr_b16 v[192:193], v3 offset:16960
    v_add_f32 v5, v5, v230
    v_add_f32 v5, v5, v231
    v_cvt_pk_bf16_f32 v220, v224, v225
    v_cvt_pk_bf16_f32 v221, v226, v227
    v_cvt_pk_bf16_f32 v222, v228, v229
    v_cvt_pk_bf16_f32 v223, v230, v231
    v_mfma_f32_32x32x16_bf16 v[88:103], v[156:159], v[216:219], v[88:103]
    ds_read_b64_tr_b16 v[194:195], v3 offset:25408
    ds_read_b64_tr_b16 v[196:197], v3 offset:16992
    ds_read_b64_tr_b16 v[198:199], v3 offset:25440
    v_mov_b32 v224, v5
    v_mbcnt_lo_u32_b32 v229, -1, 0
    v_mbcnt_hi_u32_b32 v229, -1, v229
    v_mfma_f32_32x32x16_bf16 v[8:23], v[168:171], v[220:223], v[8:23]
    v_permlane32_swap_b32 v224, v5
    v_lshl_add_u32 v200, v229, 3, s43
    v_add_f32 v5, v5, v224
    s_sub_u32 s52, s45, 66560
    s_sub_u32 s51, s44, 66560
    v_lshl_add_u32 v224, v229, 4, s52
    v_mfma_f32_32x32x16_bf16 v[24:39], v[172:175], v[220:223], v[24:39]
    ds_write_b64 v200, v[4:5]
    v_lshl_add_u32 v225, v229, 4, s51
    v_xor_b32 v201, 0x400, v200
    v_lshlrev_b32 v226, 4, v229
    v_add_u32 v226, 139264, v226
    v_mfma_f32_32x32x16_bf16 v[40:55], v[176:179], v[220:223], v[40:55]
    v_and_b32 v6, 24, v229
    v_lshrrev_b32 v231, 5, v229
    v_lshl_add_u32 v6, v6, 10, s46
    v_lshl_add_u32 v6, v231, 7, v6
    v_and_b32 v231, 7, v229
    v_lshl_add_u32 v6, v231, 4, v6
    v_mfma_f32_32x32x16_bf16 v[56:71], v[180:183], v[220:223], v[56:71]
    v_cvt_pk_bf16_f32 v8, v8, v9
    v_cvt_pk_bf16_f32 v9, v10, v11
    v_cvt_pk_bf16_f32 v10, v12, v13
    v_cvt_pk_bf16_f32 v11, v14, v15
    v_cvt_pk_bf16_f32 v12, v16, v17
    v_cvt_pk_bf16_f32 v13, v18, v19
    s_waitcnt lgkmcnt(1)
    v_mfma_f32_32x32x16_bf16 v[104:119], v[160:163], v[216:219], v[104:119]
    ds_write_b128 v224, v[8:11] offset:0
    v_cvt_pk_bf16_f32 v14, v20, v21
    v_cvt_pk_bf16_f32 v15, v22, v23
    v_cvt_pk_bf16_f32 v24, v24, v25
    v_cvt_pk_bf16_f32 v25, v26, v27
    v_mfma_f32_32x32x16_bf16 v[120:135], v[164:167], v[216:219], v[120:135]
    ds_write_b128 v224, v[12:15] offset:1024
    v_cvt_pk_bf16_f32 v26, v28, v29
    v_cvt_pk_bf16_f32 v27, v30, v31
    v_cvt_pk_bf16_f32 v28, v32, v33
    v_cvt_pk_bf16_f32 v29, v34, v35
    ds_write_b128 v224, v[24:27] offset:2048
    v_mfma_f32_32x32x16_bf16 v[72:87], v[184:187], v[220:223], v[72:87]
    v_cvt_pk_bf16_f32 v30, v36, v37
    v_cvt_pk_bf16_f32 v31, v38, v39
    v_cvt_pk_bf16_f32 v40, v40, v41
    v_cvt_pk_bf16_f32 v41, v42, v43
    ds_write_b128 v224, v[28:31] offset:3072
    v_cvt_pk_bf16_f32 v42, v44, v45
    v_mfma_f32_32x32x16_bf16 v[88:103], v[188:191], v[220:223], v[88:103]
    v_cvt_pk_bf16_f32 v43, v46, v47
    v_cvt_pk_bf16_f32 v44, v48, v49
    v_cvt_pk_bf16_f32 v45, v50, v51
    ds_write_b128 v224, v[40:43] offset:4096
    v_cvt_pk_bf16_f32 v46, v52, v53
    v_cvt_pk_bf16_f32 v47, v54, v55
    v_mfma_f32_32x32x16_bf16 v[104:119], v[192:195], v[220:223], v[104:119]
    v_cvt_pk_bf16_f32 v56, v56, v57
    v_cvt_pk_bf16_f32 v57, v58, v59
    ds_write_b128 v224, v[44:47] offset:5120
    v_cvt_pk_bf16_f32 v58, v60, v61
    v_cvt_pk_bf16_f32 v59, v62, v63
    v_mfma_f32_32x32x16_bf16 v[120:135], v[196:199], v[220:223], v[120:135]
    ds_read_b128 v[216:219], v226 offset:0
    ds_read_b128 v[220:223], v226 offset:1024
    v_cvt_pk_bf16_f32 v60, v64, v65
    v_cvt_pk_bf16_f32 v61, v66, v67
    ds_write_b128 v224, v[56:59] offset:6144
    v_cvt_pk_bf16_f32 v62, v68, v69
    v_cvt_pk_bf16_f32 v63, v70, v71
    ds_write_b128 v224, v[60:63] offset:7168
    s_waitcnt lgkmcnt(0)
    s_barrier
    ds_read_b64 v[202:203], v201
    ds_read_b128 v[16:19], v225 offset:0
    ds_read_b128 v[20:23], v225 offset:1024
    ds_read_b128 v[32:35], v225 offset:2048
    ds_read_b128 v[36:39], v225 offset:3072
    ds_read_b128 v[48:51], v225 offset:4096
    ds_read_b128 v[52:55], v225 offset:5120
    ds_read_b128 v[64:67], v225 offset:6144
    ds_read_b128 v[68:71], v225 offset:7168
    s_waitcnt lgkmcnt(8)
    v_max_f32 v204, v4, v202
    v_cmp_neq_f32 vcc, v4, v202
    v_sub_f32 v205, v4, v204
    v_sub_f32 v204, v202, v204
    v_exp_f32 v205, v205
    v_exp_f32 v204, v204
    s_cbranch_vccnz L_rare_zf
L_ret_zf:
    s_waitcnt lgkmcnt(7)
    v_mfma_f32_32x32x16_bf16 v[72:87], v[216:219], v[16:19], v[72:87]
    s_waitcnt lgkmcnt(5)
    v_mfma_f32_32x32x16_bf16 v[72:87], v[220:223], v[20:23], v[72:87]
    v_mul_f32 v5, v5, v205
    v_fmac_f32 v5, v204, v203
    v_rcp_f32 v7, v5
    v_mfma_f32_32x32x16_bf16 v[88:103], v[216:219], v[32:35], v[88:103]
    s_nop 7
    s_waitcnt lgkmcnt(0)
    v_mfma_f32_32x32x16_bf16 v[88:103], v[220:223], v[36:39], v[88:103]
    v_mfma_f32_32x32x16_bf16 v[104:119], v[216:219], v[48:51], v[104:119]
    v_mul_f32 v72, v72, v7
    v_mul_f32 v73, v73, v7
    v_mul_f32 v74, v74, v7
    v_mul_f32 v75, v75, v7
    v_mul_f32 v76, v76, v7
    v_mul_f32 v77, v77, v7
    v_mfma_f32_32x32x16_bf16 v[104:119], v[220:223], v[52:55], v[104:119]
    v_mul_f32 v78, v78, v7
    v_mul_f32 v79, v79, v7
    v_mul_f32 v80, v80, v7
    v_mul_f32 v81, v81, v7
    v_mul_f32 v82, v82, v7
    v_mul_f32 v83, v83, v7
    v_mfma_f32_32x32x16_bf16 v[120:135], v[216:219], v[64:67], v[120:135]
    v_mul_f32 v84, v84, v7
    v_mul_f32 v85, v85, v7
    v_mul_f32 v86, v86, v7
    v_mul_f32 v87, v87, v7
    v_cvt_pk_bf16_f32 v72, v72, v73
    v_cvt_pk_bf16_f32 v73, v74, v75
    v_mfma_f32_32x32x16_bf16 v[120:135], v[220:223], v[68:71], v[120:135]
    v_cvt_pk_bf16_f32 v74, v76, v77
    v_cvt_pk_bf16_f32 v75, v78, v79
    v_cvt_pk_bf16_f32 v76, v80, v81
    v_cvt_pk_bf16_f32 v77, v82, v83
    v_cvt_pk_bf16_f32 v78, v84, v85
    v_cvt_pk_bf16_f32 v79, v86, v87
    s_mov_b64 vcc, s[56:57]
    v_cndmask_b32_dpp v80, v76, v72, vcc quad_perm:[1,0,3,2] row_mask:0xf bank_mask:0xf
    v_cndmask_b32_dpp v81, v77, v73, vcc quad_perm:[1,0,3,2] row_mask:0xf bank_mask:0xf
    v_cndmask_b32_dpp v82, v78, v74, vcc quad_perm:[1,0,3,2] row_mask:0xf bank_mask:0xf
    v_cndmask_b32_dpp v83, v79, v75, vcc quad_perm:[1,0,3,2] row_mask:0xf bank_mask:0xf
    s_not_b64 vcc, vcc
    v_cndmask_b32_dpp v84, v72, v76, vcc quad_perm:[1,0,3,2] row_mask:0xf bank_mask:0xf
    v_cndmask_b32_dpp v85, v73, v77, vcc quad_perm:[1,0,3,2] row_mask:0xf bank_mask:0xf
    v_cndmask_b32_dpp v86, v74, v78, vcc quad_perm:[1,0,3,2] row_mask:0xf bank_mask:0xf
    v_cndmask_b32_dpp v87, v75, v79, vcc quad_perm:[1,0,3,2] row_mask:0xf bank_mask:0xf
    v_pk_mul_f32 v[88:89], v[88:89], v[6:7] op_sel:[0,1] op_sel_hi:[1,1]
    v_pk_mul_f32 v[90:91], v[90:91], v[6:7] op_sel:[0,1] op_sel_hi:[1,1]
    v_pk_mul_f32 v[92:93], v[92:93], v[6:7] op_sel:[0,1] op_sel_hi:[1,1]
    v_pk_mul_f32 v[94:95], v[94:95], v[6:7] op_sel:[0,1] op_sel_hi:[1,1]
    v_pk_mul_f32 v[96:97], v[96:97], v[6:7] op_sel:[0,1] op_sel_hi:[1,1]
    v_pk_mul_f32 v[98:99], v[98:99], v[6:7] op_sel:[0,1] op_sel_hi:[1,1]
    v_pk_mul_f32 v[100:101], v[100:101], v[6:7] op_sel:[0,1] op_sel_hi:[1,1]
    v_pk_mul_f32 v[102:103], v[102:103], v[6:7] op_sel:[0,1] op_sel_hi:[1,1]
    v_cvt_pk_bf16_f32 v88, v88, v89
    v_cvt_pk_bf16_f32 v89, v90, v91
    v_cvt_pk_bf16_f32 v90, v92, v93
    v_cvt_pk_bf16_f32 v91, v94, v95
    v_cvt_pk_bf16_f32 v92, v96, v97
    v_cvt_pk_bf16_f32 v93, v98, v99
    v_cvt_pk_bf16_f32 v94, v100, v101
    v_cvt_pk_bf16_f32 v95, v102, v103
    s_mov_b64 vcc, s[56:57]
    v_cndmask_b32_dpp v96, v92, v88, vcc quad_perm:[1,0,3,2] row_mask:0xf bank_mask:0xf
    v_cndmask_b32_dpp v97, v93, v89, vcc quad_perm:[1,0,3,2] row_mask:0xf bank_mask:0xf
    v_cndmask_b32_dpp v98, v94, v90, vcc quad_perm:[1,0,3,2] row_mask:0xf bank_mask:0xf
    v_cndmask_b32_dpp v99, v95, v91, vcc quad_perm:[1,0,3,2] row_mask:0xf bank_mask:0xf
    s_not_b64 vcc, vcc
    v_cndmask_b32_dpp v100, v88, v92, vcc quad_perm:[1,0,3,2] row_mask:0xf bank_mask:0xf
    v_cndmask_b32_dpp v101, v89, v93, vcc quad_perm:[1,0,3,2] row_mask:0xf bank_mask:0xf
    v_cndmask_b32_dpp v102, v90, v94, vcc quad_perm:[1,0,3,2] row_mask:0xf bank_mask:0xf
    v_cndmask_b32_dpp v103, v91, v95, vcc quad_perm:[1,0,3,2] row_mask:0xf bank_mask:0xf
    v_pk_mul_f32 v[104:105], v[104:105], v[6:7] op_sel:[0,1] op_sel_hi:[1,1]
    v_pk_mul_f32 v[106:107], v[106:107], v[6:7] op_sel:[0,1] op_sel_hi:[1,1]
    v_pk_mul_f32 v[108:109], v[108:109], v[6:7] op_sel:[0,1] op_sel_hi:[1,1]
    v_pk_mul_f32 v[110:111], v[110:111], v[6:7] op_sel:[0,1] op_sel_hi:[1,1]
    v_pk_mul_f32 v[112:113], v[112:113], v[6:7] op_sel:[0,1] op_sel_hi:[1,1]
    v_pk_mul_f32 v[114:115], v[114:115], v[6:7] op_sel:[0,1] op_sel_hi:[1,1]
    v_pk_mul_f32 v[116:117], v[116:117], v[6:7] op_sel:[0,1] op_sel_hi:[1,1]
    v_pk_mul_f32 v[118:119], v[118:119], v[6:7] op_sel:[0,1] op_sel_hi:[1,1]
    v_cvt_pk_bf16_f32 v104, v104, v105
    v_cvt_pk_bf16_f32 v105, v106, v107
    v_cvt_pk_bf16_f32 v106, v108, v109
    v_cvt_pk_bf16_f32 v107, v110, v111
    v_cvt_pk_bf16_f32 v108, v112, v113
    v_cvt_pk_bf16_f32 v109, v114, v115
    v_cvt_pk_bf16_f32 v110, v116, v117
    v_cvt_pk_bf16_f32 v111, v118, v119
    s_mov_b64 vcc, s[56:57]
    v_cndmask_b32_dpp v112, v108, v104, vcc quad_perm:[1,0,3,2] row_mask:0xf bank_mask:0xf
    v_cndmask_b32_dpp v113, v109, v105, vcc quad_perm:[1,0,3,2] row_mask:0xf bank_mask:0xf
    v_cndmask_b32_dpp v114, v110, v106, vcc quad_perm:[1,0,3,2] row_mask:0xf bank_mask:0xf
    v_cndmask_b32_dpp v115, v111, v107, vcc quad_perm:[1,0,3,2] row_mask:0xf bank_mask:0xf
    s_not_b64 vcc, vcc
    v_cndmask_b32_dpp v116, v104, v108, vcc quad_perm:[1,0,3,2] row_mask:0xf bank_mask:0xf
    v_cndmask_b32_dpp v117, v105, v109, vcc quad_perm:[1,0,3,2] row_mask:0xf bank_mask:0xf
    v_cndmask_b32_dpp v118, v106, v110, vcc quad_perm:[1,0,3,2] row_mask:0xf bank_mask:0xf
    v_cndmask_b32_dpp v119, v107, v111, vcc quad_perm:[1,0,3,2] row_mask:0xf bank_mask:0xf
    v_pk_mul_f32 v[120:121], v[120:121], v[6:7] op_sel:[0,1] op_sel_hi:[1,1]
    v_pk_mul_f32 v[122:123], v[122:123], v[6:7] op_sel:[0,1] op_sel_hi:[1,1]
    v_pk_mul_f32 v[124:125], v[124:125], v[6:7] op_sel:[0,1] op_sel_hi:[1,1]
    v_pk_mul_f32 v[126:127], v[126:127], v[6:7] op_sel:[0,1] op_sel_hi:[1,1]
    v_pk_mul_f32 v[128:129], v[128:129], v[6:7] op_sel:[0,1] op_sel_hi:[1,1]
    v_pk_mul_f32 v[130:131], v[130:131], v[6:7] op_sel:[0,1] op_sel_hi:[1,1]
    v_pk_mul_f32 v[132:133], v[132:133], v[6:7] op_sel:[0,1] op_sel_hi:[1,1]
    v_pk_mul_f32 v[134:135], v[134:135], v[6:7] op_sel:[0,1] op_sel_hi:[1,1]
    v_cvt_pk_bf16_f32 v120, v120, v121
    v_cvt_pk_bf16_f32 v121, v122, v123
    v_cvt_pk_bf16_f32 v122, v124, v125
    v_cvt_pk_bf16_f32 v123, v126, v127
    v_cvt_pk_bf16_f32 v124, v128, v129
    v_cvt_pk_bf16_f32 v125, v130, v131
    v_cvt_pk_bf16_f32 v126, v132, v133
    v_cvt_pk_bf16_f32 v127, v134, v135
    s_mov_b64 vcc, s[56:57]
    v_cndmask_b32_dpp v128, v124, v120, vcc quad_perm:[1,0,3,2] row_mask:0xf bank_mask:0xf
    v_cndmask_b32_dpp v129, v125, v121, vcc quad_perm:[1,0,3,2] row_mask:0xf bank_mask:0xf
    v_cndmask_b32_dpp v130, v126, v122, vcc quad_perm:[1,0,3,2] row_mask:0xf bank_mask:0xf
    v_cndmask_b32_dpp v131, v127, v123, vcc quad_perm:[1,0,3,2] row_mask:0xf bank_mask:0xf
    s_not_b64 vcc, vcc
    v_cndmask_b32_dpp v132, v120, v124, vcc quad_perm:[1,0,3,2] row_mask:0xf bank_mask:0xf
    v_cndmask_b32_dpp v133, v121, v125, vcc quad_perm:[1,0,3,2] row_mask:0xf bank_mask:0xf
    v_cndmask_b32_dpp v134, v122, v126, vcc quad_perm:[1,0,3,2] row_mask:0xf bank_mask:0xf
    v_cndmask_b32_dpp v135, v123, v127, vcc quad_perm:[1,0,3,2] row_mask:0xf bank_mask:0xf
    s_mov_b64 vcc, s[58:59]
    s_add_u32 s53, s37, 4096
    v_cndmask_b32_dpp v16, v96, v80, vcc quad_perm:[2,3,0,1] row_mask:0xf bank_mask:0xf
    v_cndmask_b32_dpp v17, v97, v81, vcc quad_perm:[2,3,0,1] row_mask:0xf bank_mask:0xf
    v_cndmask_b32_dpp v18, v98, v82, vcc quad_perm:[2,3,0,1] row_mask:0xf bank_mask:0xf
    v_cndmask_b32_dpp v19, v99, v83, vcc quad_perm:[2,3,0,1] row_mask:0xf bank_mask:0xf
    v_cndmask_b32_dpp v48, v128, v112, vcc quad_perm:[2,3,0,1] row_mask:0xf bank_mask:0xf
    v_cndmask_b32_dpp v49, v129, v113, vcc quad_perm:[2,3,0,1] row_mask:0xf bank_mask:0xf
    v_cndmask_b32_dpp v50, v130, v114, vcc quad_perm:[2,3,0,1] row_mask:0xf bank_mask:0xf
    v_cndmask_b32_dpp v51, v131, v115, vcc quad_perm:[2,3,0,1] row_mask:0xf bank_mask:0xf
    s_mov_b32 vcc_lo, 0x0f0f0f0f
    s_mov_b32 vcc_hi, 0x0f0f0f0f
    v_cndmask_b32_dpp v12, v48, v16, vcc row_shr:4 row_mask:0xf bank_mask:0xf bound_ctrl:1
    v_cndmask_b32_dpp v13, v49, v17, vcc row_shr:4 row_mask:0xf bank_mask:0xf bound_ctrl:1
    v_cndmask_b32_dpp v14, v50, v18, vcc row_shr:4 row_mask:0xf bank_mask:0xf bound_ctrl:1
    v_cndmask_b32_dpp v15, v51, v19, vcc row_shr:4 row_mask:0xf bank_mask:0xf bound_ctrl:1
    buffer_store_dwordx4 v[12:15], v6, s[16:19], s37 offen offset:0 sc1
    v_mov_b32_dpp v48, v16 row_shl:4 row_mask:0xf bank_mask:0x5
    v_mov_b32_dpp v49, v17 row_shl:4 row_mask:0xf bank_mask:0x5
    v_mov_b32_dpp v50, v18 row_shl:4 row_mask:0xf bank_mask:0x5
    v_mov_b32_dpp v51, v19 row_shl:4 row_mask:0xf bank_mask:0x5
    buffer_store_dwordx4 v[48:51], v6, s[16:19], s53 offen offset:0 sc1
    s_mov_b64 vcc, s[58:59]
    v_cndmask_b32_dpp v20, v100, v84, vcc quad_perm:[2,3,0,1] row_mask:0xf bank_mask:0xf
    v_cndmask_b32_dpp v21, v101, v85, vcc quad_perm:[2,3,0,1] row_mask:0xf bank_mask:0xf
    v_cndmask_b32_dpp v22, v102, v86, vcc quad_perm:[2,3,0,1] row_mask:0xf bank_mask:0xf
    v_cndmask_b32_dpp v23, v103, v87, vcc quad_perm:[2,3,0,1] row_mask:0xf bank_mask:0xf
    v_cndmask_b32_dpp v52, v132, v116, vcc quad_perm:[2,3,0,1] row_mask:0xf bank_mask:0xf
    v_cndmask_b32_dpp v53, v133, v117, vcc quad_perm:[2,3,0,1] row_mask:0xf bank_mask:0xf
    v_cndmask_b32_dpp v54, v134, v118, vcc quad_perm:[2,3,0,1] row_mask:0xf bank_mask:0xf
    v_cndmask_b32_dpp v55, v135, v119, vcc quad_perm:[2,3,0,1] row_mask:0xf bank_mask:0xf
    s_mov_b32 vcc_lo, 0x0f0f0f0f
    s_mov_b32 vcc_hi, 0x0f0f0f0f
    v_cndmask_b32_dpp v28, v52, v20, vcc row_shr:4 row_mask:0xf bank_mask:0xf bound_ctrl:1
    v_cndmask_b32_dpp v29, v53, v21, vcc row_shr:4 row_mask:0xf bank_mask:0xf bound_ctrl:1
    v_cndmask_b32_dpp v30, v54, v22, vcc row_shr:4 row_mask:0xf bank_mask:0xf bound_ctrl:1
    v_cndmask_b32_dpp v31, v55, v23, vcc row_shr:4 row_mask:0xf bank_mask:0xf bound_ctrl:1
    buffer_store_dwordx4 v[28:31], v6, s[16:19], s37 offen offset:1024 sc1
    v_mov_b32_dpp v52, v20 row_shl:4 row_mask:0xf bank_mask:0x5
    v_mov_b32_dpp v53, v21 row_shl:4 row_mask:0xf bank_mask:0x5
    v_mov_b32_dpp v54, v22 row_shl:4 row_mask:0xf bank_mask:0x5
    v_mov_b32_dpp v55, v23 row_shl:4 row_mask:0xf bank_mask:0x5
    buffer_store_dwordx4 v[52:55], v6, s[16:19], s53 offen offset:1024 sc1
    s_mov_b64 vcc, s[58:59]
    s_not_b64 vcc, vcc
    v_cndmask_b32_dpp v32, v80, v96, vcc quad_perm:[2,3,0,1] row_mask:0xf bank_mask:0xf
    v_cndmask_b32_dpp v33, v81, v97, vcc quad_perm:[2,3,0,1] row_mask:0xf bank_mask:0xf
    v_cndmask_b32_dpp v34, v82, v98, vcc quad_perm:[2,3,0,1] row_mask:0xf bank_mask:0xf
    v_cndmask_b32_dpp v35, v83, v99, vcc quad_perm:[2,3,0,1] row_mask:0xf bank_mask:0xf
    v_cndmask_b32_dpp v64, v112, v128, vcc quad_perm:[2,3,0,1] row_mask:0xf bank_mask:0xf
    v_cndmask_b32_dpp v65, v113, v129, vcc quad_perm:[2,3,0,1] row_mask:0xf bank_mask:0xf
    v_cndmask_b32_dpp v66, v114, v130, vcc quad_perm:[2,3,0,1] row_mask:0xf bank_mask:0xf
    v_cndmask_b32_dpp v67, v115, v131, vcc quad_perm:[2,3,0,1] row_mask:0xf bank_mask:0xf
    s_mov_b32 vcc_lo, 0x0f0f0f0f
    s_mov_b32 vcc_hi, 0x0f0f0f0f
    v_cndmask_b32_dpp v44, v64, v32, vcc row_shr:4 row_mask:0xf bank_mask:0xf bound_ctrl:1
    v_cndmask_b32_dpp v45, v65, v33, vcc row_shr:4 row_mask:0xf bank_mask:0xf bound_ctrl:1
    v_cndmask_b32_dpp v46, v66, v34, vcc row_shr:4 row_mask:0xf bank_mask:0xf bound_ctrl:1
    v_cndmask_b32_dpp v47, v67, v35, vcc row_shr:4 row_mask:0xf bank_mask:0xf bound_ctrl:1
    buffer_store_dwordx4 v[44:47], v6, s[16:19], s37 offen offset:2048 sc1
    v_mov_b32_dpp v64, v32 row_shl:4 row_mask:0xf bank_mask:0x5
    v_mov_b32_dpp v65, v33 row_shl:4 row_mask:0xf bank_mask:0x5
    v_mov_b32_dpp v66, v34 row_shl:4 row_mask:0xf bank_mask:0x5
    v_mov_b32_dpp v67, v35 row_shl:4 row_mask:0xf bank_mask:0x5
    buffer_store_dwordx4 v[64:67], v6, s[16:19], s53 offen offset:2048 sc1
    s_not_b64 vcc, s[58:59]
    v_cndmask_b32_dpp v36, v84, v100, vcc quad_perm:[2,3,0,1] row_mask:0xf bank_mask:0xf
    v_cndmask_b32_dpp v37, v85, v101, vcc quad_perm:[2,3,0,1] row_mask:0xf bank_mask:0xf
    v_cndmask_b32_dpp v38, v86, v102, vcc quad_perm:[2,3,0,1] row_mask:0xf bank_mask:0xf
    v_cndmask_b32_dpp v39, v87, v103, vcc quad_perm:[2,3,0,1] row_mask:0xf bank_mask:0xf
    v_cndmask_b32_dpp v68, v116, v132, vcc quad_perm:[2,3,0,1] row_mask:0xf bank_mask:0xf
    v_cndmask_b32_dpp v69, v117, v133, vcc quad_perm:[2,3,0,1] row_mask:0xf bank_mask:0xf
    v_cndmask_b32_dpp v70, v118, v134, vcc quad_perm:[2,3,0,1] row_mask:0xf bank_mask:0xf
    v_cndmask_b32_dpp v71, v119, v135, vcc quad_perm:[2,3,0,1] row_mask:0xf bank_mask:0xf
    s_mov_b32 vcc_lo, 0x0f0f0f0f
    s_mov_b32 vcc_hi, 0x0f0f0f0f
    v_cndmask_b32_dpp v60, v68, v36, vcc row_shr:4 row_mask:0xf bank_mask:0xf bound_ctrl:1
    v_cndmask_b32_dpp v61, v69, v37, vcc row_shr:4 row_mask:0xf bank_mask:0xf bound_ctrl:1
    v_cndmask_b32_dpp v62, v70, v38, vcc row_shr:4 row_mask:0xf bank_mask:0xf bound_ctrl:1
    v_cndmask_b32_dpp v63, v71, v39, vcc row_shr:4 row_mask:0xf bank_mask:0xf bound_ctrl:1
    buffer_store_dwordx4 v[60:63], v6, s[16:19], s37 offen offset:3072 sc1
    v_mov_b32_dpp v68, v36 row_shl:4 row_mask:0xf bank_mask:0x5
    v_mov_b32_dpp v69, v37 row_shl:4 row_mask:0xf bank_mask:0x5
    v_mov_b32_dpp v70, v38 row_shl:4 row_mask:0xf bank_mask:0x5
    v_mov_b32_dpp v71, v39 row_shl:4 row_mask:0xf bank_mask:0x5
    buffer_store_dwordx4 v[68:71], v6, s[16:19], s53 offen offset:3072 sc1
    s_branch L_out
L_rare_zd:
    s_nop 12
    v_mul_f32 v8, v8, v7
    v_mul_f32 v9, v9, v7
    v_mul_f32 v10, v10, v7
    v_mul_f32 v11, v11, v7
    v_mul_f32 v12, v12, v7
    v_mul_f32 v13, v13, v7
    v_mul_f32 v14, v14, v7
    v_mul_f32 v15, v15, v7
    v_mul_f32 v16, v16, v7
    v_mul_f32 v17, v17, v7
    v_mul_f32 v18, v18, v7
    v_mul_f32 v19, v19, v7
    v_mul_f32 v20, v20, v7
    v_mul_f32 v21, v21, v7
    v_mul_f32 v22, v22, v7
    v_mul_f32 v23, v23, v7
    v_mul_f32 v24, v24, v7
    v_mul_f32 v25, v25, v7
    v_mul_f32 v26, v26, v7
    v_mul_f32 v27, v27, v7
    v_mul_f32 v28, v28, v7
    v_mul_f32 v29, v29, v7
    v_mul_f32 v30, v30, v7
    v_mul_f32 v31, v31, v7
    v_mul_f32 v32, v32, v7
    v_mul_f32 v33, v33, v7
    v_mul_f32 v34, v34, v7
    v_mul_f32 v35, v35, v7
    v_mul_f32 v36, v36, v7
    v_mul_f32 v37, v37, v7
    v_mul_f32 v38, v38, v7
    v_mul_f32 v39, v39, v7
    v_mul_f32 v40, v40, v7
    v_mul_f32 v41, v41, v7
    v_mul_f32 v42, v42, v7
    v_mul_f32 v43, v43, v7
    v_mul_f32 v44, v44, v7
    v_mul_f32 v45, v45, v7
    v_mul_f32 v46, v46, v7
    v_mul_f32 v47, v47, v7
    v_mul_f32 v48, v48, v7
    v_mul_f32 v49, v49, v7
    v_mul_f32 v50, v50, v7
    v_mul_f32 v51, v51, v7
    v_mul_f32 v52, v52, v7
    v_mul_f32 v53, v53, v7
    v_mul_f32 v54, v54, v7
    v_mul_f32 v55, v55, v7
    v_mul_f32 v56, v56, v7
    v_mul_f32 v57, v57, v7
    v_mul_f32 v58, v58, v7
    v_mul_f32 v59, v59, v7
    v_mul_f32 v60, v60, v7
    v_mul_f32 v61, v61, v7
    v_mul_f32 v62, v62, v7
    v_mul_f32 v63, v63, v7
    v_mul_f32 v64, v64, v7
    v_mul_f32 v65, v65, v7
    v_mul_f32 v66, v66, v7
    v_mul_f32 v67, v67, v7
    v_mul_f32 v68, v68, v7
    v_mul_f32 v69, v69, v7
    v_mul_f32 v70, v70, v7
    v_mul_f32 v71, v71, v7
    v_mul_f32 v72, v72, v7
    v_mul_f32 v73, v73, v7
    v_mul_f32 v74, v74, v7
    v_mul_f32 v75, v75, v7
    v_mul_f32 v76, v76, v7
    v_mul_f32 v77, v77, v7
    v_mul_f32 v78, v78, v7
    v_mul_f32 v79, v79, v7
    v_mul_f32 v80, v80, v7
    v_mul_f32 v81, v81, v7
    v_mul_f32 v82, v82, v7
    v_mul_f32 v83, v83, v7
    v_mul_f32 v84, v84, v7
    v_mul_f32 v85, v85, v7
    v_mul_f32 v86, v86, v7
    v_mul_f32 v87, v87, v7
    v_mul_f32 v88, v88, v7
    v_mul_f32 v89, v89, v7
    v_mul_f32 v90, v90, v7
    v_mul_f32 v91, v91, v7
    v_mul_f32 v92, v92, v7
    v_mul_f32 v93, v93, v7
    v_mul_f32 v94, v94, v7
    v_mul_f32 v95, v95, v7
    v_mul_f32 v96, v96, v7
    v_mul_f32 v97, v97, v7
    v_mul_f32 v98, v98, v7
    v_mul_f32 v99, v99, v7
    v_mul_f32 v100, v100, v7
    v_mul_f32 v101, v101, v7
    v_mul_f32 v102, v102, v7
    v_mul_f32 v103, v103, v7
    v_mul_f32 v104, v104, v7
    v_mul_f32 v105, v105, v7
    v_mul_f32 v106, v106, v7
    v_mul_f32 v107, v107, v7
    v_mul_f32 v108, v108, v7
    v_mul_f32 v109, v109, v7
    v_mul_f32 v110, v110, v7
    v_mul_f32 v111, v111, v7
    v_mul_f32 v112, v112, v7
    v_mul_f32 v113, v113, v7
    v_mul_f32 v114, v114, v7
    v_mul_f32 v115, v115, v7
    v_mul_f32 v116, v116, v7
    v_mul_f32 v117, v117, v7
    v_mul_f32 v118, v118, v7
    v_mul_f32 v119, v119, v7
    v_mul_f32 v120, v120, v7
    v_mul_f32 v121, v121, v7
    v_mul_f32 v122, v122, v7
    v_mul_f32 v123, v123, v7
    v_mul_f32 v124, v124, v7
    v_mul_f32 v125, v125, v7
    v_mul_f32 v126, v126, v7
    v_mul_f32 v127, v127, v7
    v_mul_f32 v128, v128, v7
    v_mul_f32 v129, v129, v7
    v_mul_f32 v130, v130, v7
    v_mul_f32 v131, v131, v7
    v_mul_f32 v132, v132, v7
    v_mul_f32 v133, v133, v7
    v_mul_f32 v134, v134, v7
    v_mul_f32 v135, v135, v7
    s_branch L_ret_zd
L_rare_zf:
    s_waitcnt lgkmcnt(0)
    s_nop 12
    v_mul_f32 v72, v72, v205
    v_mul_f32 v73, v73, v205
    v_mul_f32 v74, v74, v205
    v_mul_f32 v75, v75, v205
    v_mul_f32 v76, v76, v205
    v_mul_f32 v77, v77, v205
    v_mul_f32 v78, v78, v205
    v_mul_f32 v79, v79, v205
    v_mul_f32 v80, v80, v205
    v_mul_f32 v81, v81, v205
    v_mul_f32 v82, v82, v205
    v_mul_f32 v83, v83, v205
    v_mul_f32 v84, v84, v205
    v_mul_f32 v85, v85, v205
    v_mul_f32 v86, v86, v205
    v_mul_f32 v87, v87, v205
    v_mul_f32 v88, v88, v205
    v_mul_f32 v89, v89, v205
    v_mul_f32 v90, v90, v205
    v_mul_f32 v91, v91, v205
    v_mul_f32 v92, v92, v205
    v_mul_f32 v93, v93, v205
    v_mul_f32 v94, v94, v205
    v_mul_f32 v95, v95, v205
    v_mul_f32 v96, v96, v205
    v_mul_f32 v97, v97, v205
    v_mul_f32 v98, v98, v205
    v_mul_f32 v99, v99, v205
    v_mul_f32 v100, v100, v205
    v_mul_f32 v101, v101, v205
    v_mul_f32 v102, v102, v205
    v_mul_f32 v103, v103, v205
    v_mul_f32 v104, v104, v205
    v_mul_f32 v105, v105, v205
    v_mul_f32 v106, v106, v205
    v_mul_f32 v107, v107, v205
    v_mul_f32 v108, v108, v205
    v_mul_f32 v109, v109, v205
    v_mul_f32 v110, v110, v205
    v_mul_f32 v111, v111, v205
    v_mul_f32 v112, v112, v205
    v_mul_f32 v113, v113, v205
    v_mul_f32 v114, v114, v205
    v_mul_f32 v115, v115, v205
    v_mul_f32 v116, v116, v205
    v_mul_f32 v117, v117, v205
    v_mul_f32 v118, v118, v205
    v_mul_f32 v119, v119, v205
    v_mul_f32 v120, v120, v205
    v_mul_f32 v121, v121, v205
    v_mul_f32 v122, v122, v205
    v_mul_f32 v123, v123, v205
    v_mul_f32 v124, v124, v205
    v_mul_f32 v125, v125, v205
    v_mul_f32 v126, v126, v205
    v_mul_f32 v127, v127, v205
    v_mul_f32 v128, v128, v205
    v_mul_f32 v129, v129, v205
    v_mul_f32 v130, v130, v205
    v_mul_f32 v131, v131, v205
    v_mul_f32 v132, v132, v205
    v_mul_f32 v133, v133, v205
    v_mul_f32 v134, v134, v205
    v_mul_f32 v135, v135, v205
    v_lshlrev_b32 v206, 16, v16
    v_and_b32 v207, 0xffff0000, v16
    v_mul_f32 v206, v206, v204
    v_mul_f32 v207, v207, v204
    v_cvt_pk_bf16_f32 v16, v206, v207
    v_lshlrev_b32 v206, 16, v17
    v_and_b32 v207, 0xffff0000, v17
    v_mul_f32 v206, v206, v204
    v_mul_f32 v207, v207, v204
    v_cvt_pk_bf16_f32 v17, v206, v207
    v_lshlrev_b32 v206, 16, v18
    v_and_b32 v207, 0xffff0000, v18
    v_mul_f32 v206, v206, v204
    v_mul_f32 v207, v207, v204
    v_cvt_pk_bf16_f32 v18, v206, v207
    v_lshlrev_b32 v206, 16, v19
    v_and_b32 v207, 0xffff0000, v19
    v_mul_f32 v206, v206, v204
    v_mul_f32 v207, v207, v204
    v_cvt_pk_bf16_f32 v19, v206, v207
    v_lshlrev_b32 v206, 16, v20
    v_and_b32 v207, 0xffff0000, v20
    v_mul_f32 v206, v206, v204
    v_mul_f32 v207, v207, v204
    v_cvt_pk_bf16_f32 v20, v206, v207
    v_lshlrev_b32 v206, 16, v21
    v_and_b32 v207, 0xffff0000, v21
    v_mul_f32 v206, v206, v204
    v_mul_f32 v207, v207, v204
    v_cvt_pk_bf16_f32 v21, v206, v207
    v_lshlrev_b32 v206, 16, v22
    v_and_b32 v207, 0xffff0000, v22
    v_mul_f32 v206, v206, v204
    v_mul_f32 v207, v207, v204
    v_cvt_pk_bf16_f32 v22, v206, v207
    v_lshlrev_b32 v206, 16, v23
    v_and_b32 v207, 0xffff0000, v23
    v_mul_f32 v206, v206, v204
    v_mul_f32 v207, v207, v204
    v_cvt_pk_bf16_f32 v23, v206, v207
    v_lshlrev_b32 v206, 16, v32
    v_and_b32 v207, 0xffff0000, v32
    v_mul_f32 v206, v206, v204
    v_mul_f32 v207, v207, v204
    v_cvt_pk_bf16_f32 v32, v206, v207
    v_lshlrev_b32 v206, 16, v33
    v_and_b32 v207, 0xffff0000, v33
    v_mul_f32 v206, v206, v204
    v_mul_f32 v207, v207, v204
    v_cvt_pk_bf16_f32 v33, v206, v207
    v_lshlrev_b32 v206, 16, v34
    v_and_b32 v207, 0xffff0000, v34
    v_mul_f32 v206, v206, v204
    v_mul_f32 v207, v207, v204
    v_cvt_pk_bf16_f32 v34, v206, v207
    v_lshlrev_b32 v206, 16, v35
    v_and_b32 v207, 0xffff0000, v35
    v_mul_f32 v206, v206, v204
    v_mul_f32 v207, v207, v204
    v_cvt_pk_bf16_f32 v35, v206, v207
    v_lshlrev_b32 v206, 16, v36
    v_and_b32 v207, 0xffff0000, v36
    v_mul_f32 v206, v206, v204
    v_mul_f32 v207, v207, v204
    v_cvt_pk_bf16_f32 v36, v206, v207
    v_lshlrev_b32 v206, 16, v37
    v_and_b32 v207, 0xffff0000, v37
    v_mul_f32 v206, v206, v204
    v_mul_f32 v207, v207, v204
    v_cvt_pk_bf16_f32 v37, v206, v207
    v_lshlrev_b32 v206, 16, v38
    v_and_b32 v207, 0xffff0000, v38
    v_mul_f32 v206, v206, v204
    v_mul_f32 v207, v207, v204
    v_cvt_pk_bf16_f32 v38, v206, v207
    v_lshlrev_b32 v206, 16, v39
    v_and_b32 v207, 0xffff0000, v39
    v_mul_f32 v206, v206, v204
    v_mul_f32 v207, v207, v204
    v_cvt_pk_bf16_f32 v39, v206, v207
    v_lshlrev_b32 v206, 16, v48
    v_and_b32 v207, 0xffff0000, v48
    v_mul_f32 v206, v206, v204
    v_mul_f32 v207, v207, v204
    v_cvt_pk_bf16_f32 v48, v206, v207
    v_lshlrev_b32 v206, 16, v49
    v_and_b32 v207, 0xffff0000, v49
    v_mul_f32 v206, v206, v204
    v_mul_f32 v207, v207, v204
    v_cvt_pk_bf16_f32 v49, v206, v207
    v_lshlrev_b32 v206, 16, v50
    v_and_b32 v207, 0xffff0000, v50
    v_mul_f32 v206, v206, v204
    v_mul_f32 v207, v207, v204
    v_cvt_pk_bf16_f32 v50, v206, v207
    v_lshlrev_b32 v206, 16, v51
    v_and_b32 v207, 0xffff0000, v51
    v_mul_f32 v206, v206, v204
    v_mul_f32 v207, v207, v204
    v_cvt_pk_bf16_f32 v51, v206, v207
    v_lshlrev_b32 v206, 16, v52
    v_and_b32 v207, 0xffff0000, v52
    v_mul_f32 v206, v206, v204
    v_mul_f32 v207, v207, v204
    v_cvt_pk_bf16_f32 v52, v206, v207
    v_lshlrev_b32 v206, 16, v53
    v_and_b32 v207, 0xffff0000, v53
    v_mul_f32 v206, v206, v204
    v_mul_f32 v207, v207, v204
    v_cvt_pk_bf16_f32 v53, v206, v207
    v_lshlrev_b32 v206, 16, v54
    v_and_b32 v207, 0xffff0000, v54
    v_mul_f32 v206, v206, v204
    v_mul_f32 v207, v207, v204
    v_cvt_pk_bf16_f32 v54, v206, v207
    v_lshlrev_b32 v206, 16, v55
    v_and_b32 v207, 0xffff0000, v55
    v_mul_f32 v206, v206, v204
    v_mul_f32 v207, v207, v204
    v_cvt_pk_bf16_f32 v55, v206, v207
    v_lshlrev_b32 v206, 16, v64
    v_and_b32 v207, 0xffff0000, v64
    v_mul_f32 v206, v206, v204
    v_mul_f32 v207, v207, v204
    v_cvt_pk_bf16_f32 v64, v206, v207
    v_lshlrev_b32 v206, 16, v65
    v_and_b32 v207, 0xffff0000, v65
    v_mul_f32 v206, v206, v204
    v_mul_f32 v207, v207, v204
    v_cvt_pk_bf16_f32 v65, v206, v207
    v_lshlrev_b32 v206, 16, v66
    v_and_b32 v207, 0xffff0000, v66
    v_mul_f32 v206, v206, v204
    v_mul_f32 v207, v207, v204
    v_cvt_pk_bf16_f32 v66, v206, v207
    v_lshlrev_b32 v206, 16, v67
    v_and_b32 v207, 0xffff0000, v67
    v_mul_f32 v206, v206, v204
    v_mul_f32 v207, v207, v204
    v_cvt_pk_bf16_f32 v67, v206, v207
    v_lshlrev_b32 v206, 16, v68
    v_and_b32 v207, 0xffff0000, v68
    v_mul_f32 v206, v206, v204
    v_mul_f32 v207, v207, v204
    v_cvt_pk_bf16_f32 v68, v206, v207
    v_lshlrev_b32 v206, 16, v69
    v_and_b32 v207, 0xffff0000, v69
    v_mul_f32 v206, v206, v204
    v_mul_f32 v207, v207, v204
    v_cvt_pk_bf16_f32 v69, v206, v207
    v_lshlrev_b32 v206, 16, v70
    v_and_b32 v207, 0xffff0000, v70
    v_mul_f32 v206, v206, v204
    v_mul_f32 v207, v207, v204
    v_cvt_pk_bf16_f32 v70, v206, v207
    v_lshlrev_b32 v206, 16, v71
    v_and_b32 v207, 0xffff0000, v71
    v_mul_f32 v206, v206, v204
    v_mul_f32 v207, v207, v204
    v_cvt_pk_bf16_f32 v71, v206, v207
    s_nop 1
    s_branch L_ret_zf
    .p2align 3
L_xd1:
    v_add_u32 v232, s42, v1
    ds_read_b128 v[136:139], v232 offset:0
    ds_read_b128 v[140:143], v232 offset:32
    ds_read_b128 v[144:147], v232 offset:64
    ds_read_b128 v[148:151], v232 offset:96
    ds_read_b128 v[152:155], v232 offset:128
    ds_read_b128 v[156:159], v232 offset:160
    ds_read_b128 v[160:163], v232 offset:192
    ds_read_b128 v[164:167], v232 offset:224
    v_add_u32 v2, s39, v2
    v_add_u32 v3, s39, v3
    s_sub_u32 s39, 0, s39
    v_exp_f32 v224, v224
    v_exp_f32 v225, v225
    ds_read_b128 v[168:171], v232 offset:256
    v_exp_f32 v226, v226
    v_add_f32 v5, v5, v224
    ds_read_b128 v[172:175], v232 offset:288
    v_exp_f32 v227, v227
    v_add_f32 v5, v5, v225
    ds_read_b128 v[176:179], v232 offset:320
    v_exp_f32 v228, v228
    v_add_f32 v5, v5, v226
    ds_read_b128 v[180:183], v232 offset:352
    v_exp_f32 v229, v229
    v_add_f32 v5, v5, v227
    ds_read_b128 v[184:187], v232 offset:384
    v_exp_f32 v230, v230
    v_add_f32 v5, v5, v228
    ds_read_b128 v[188:191], v232 offset:416
    v_exp_f32 v231, v231
    v_add_f32 v5, v5, v229
    ds_read_b128 v[192:195], v232 offset:448
    v_add_f32 v5, v5, v230
    v_add_f32 v5, v5, v231
    s_waitcnt lgkmcnt(6)
    ds_read_b128 v[196:199], v232 offset:480
    v_cvt_pk_bf16_f32 v220, v224, v225
    v_cvt_pk_bf16_f32 v221, v226, v227
    v_cvt_pk_bf16_f32 v222, v228, v229
    v_cvt_pk_bf16_f32 v223, v230, v231
    v_mov_b32 v224, v5
    v_mbcnt_lo_u32_b32 v6, -1, 0
    v_mbcnt_hi_u32_b32 v6, -1, v6
    v_permlane32_swap_b32 v224, v5
    v_lshl_add_u32 v6, v6, 3, s43
    v_add_f32 v5, v5, v224
    ds_write_b64 v6, v[4:5]
    v_xor_b32 v6, 0x400, v6
    s_waitcnt lgkmcnt(0)
    s_barrier
    ds_read_b64_tr_b16 v[232:233], v2 offset:0
    ds_read_b64_tr_b16 v[234:235], v2 offset:8448
    ds_read_b64_tr_b16 v[236:237], v2 offset:32
    ds_read_b64_tr_b16 v[238:239], v2 offset:8480
    ds_read_b64_tr_b16 v[240:241], v2 offset:64
    ds_read_b64_tr_b16 v[242:243], v2 offset:8512
    ds_read_b64_tr_b16 v[244:245], v2 offset:96
    ds_read_b64_tr_b16 v[246:247], v2 offset:8544
    ds_read_b64_tr_b16 v[252:253], v3 offset:0
    ds_read_b64_tr_b16 v[254:255], v3 offset:8448
    v_add_u32 v1, s38, v1
    s_sub_u32 s38, 0, s38
    s_waitcnt lgkmcnt(8)
    v_mfma_f32_32x32x16_bf16 v[8:23], v[232:235], v[216:219], 0
    ds_read_b64_tr_b16 v[232:233], v3 offset:32
    ds_read_b64_tr_b16 v[234:235], v3 offset:8480
    s_waitcnt lgkmcnt(8)
    v_mfma_f32_32x32x16_bf16 v[24:39], v[236:239], v[216:219], 0
    ds_read_b64_tr_b16 v[236:237], v3 offset:64
    ds_read_b64_tr_b16 v[238:239], v3 offset:8512
    ds_read_b64 v[224:225], v6
    s_waitcnt lgkmcnt(9)
    v_mfma_f32_32x32x16_bf16 v[40:55], v[240:243], v[216:219], 0
    ds_read_b64_tr_b16 v[240:241], v3 offset:96
    ds_read_b64_tr_b16 v[242:243], v3 offset:8544
    s_waitcnt lgkmcnt(7)
    v_mfma_f32_32x32x16_bf16 v[56:71], v[244:247], v[216:219], 0
    ds_read_b64_tr_b16 v[244:245], v2 offset:16896
    ds_read_b64_tr_b16 v[246:247], v2 offset:25344
    ds_read_b64_tr_b16 v[248:249], v2 offset:16928
    ds_read_b64_tr_b16 v[250:251], v2 offset:25376
    v_mfma_f32_32x32x16_bf16 v[72:87], v[252:255], v[216:219], 0
    ds_read_b64_tr_b16 v[252:253], v2 offset:16960
    ds_read_b64_tr_b16 v[254:255], v2 offset:25408
    s_waitcnt lgkmcnt(8)
    v_mfma_f32_32x32x16_bf16 v[88:103], v[232:235], v[216:219], 0
    ds_read_b64_tr_b16 v[232:233], v2 offset:16992
    ds_read_b64_tr_b16 v[234:235], v2 offset:25440
    v_cmp_neq_f32 vcc, v4, v224
    v_max_f32 v226, v4, v224
    v_mfma_f32_32x32x16_bf16 v[104:119], v[236:239], v[216:219], 0
    v_sub_f32 v227, v4, v226
    v_sub_f32 v224, v224, v226
    v_exp_f32 v227, v227
    s_waitcnt lgkmcnt(4)
    v_mfma_f32_32x32x16_bf16 v[120:135], v[240:243], v[216:219], 0
    ds_read_b64_tr_b16 v[240:241], v3 offset:16896
    ds_read_b64_tr_b16 v[242:243], v3 offset:25344
    v_exp_f32 v224, v224
    v_mfma_f32_32x32x16_bf16 v[8:23], v[244:247], v[220:223], v[8:23]
    ds_read_b64_tr_b16 v[244:245], v3 offset:16928
    ds_read_b64_tr_b16 v[246:247], v3 offset:25376
    v_mul_f32 v5, v5, v227
    v_fmac_f32 v5, v224, v225
    v_mfma_f32_32x32x16_bf16 v[24:39], v[248:251], v[220:223], v[24:39]
    ds_read_b64_tr_b16 v[248:249], v3 offset:16960
    ds_read_b64_tr_b16 v[250:251], v3 offset:25408
    v_rcp_f32 v7, v5
    s_waitcnt lgkmcnt(6)
    v_mfma_f32_32x32x16_bf16 v[40:55], v[252:255], v[220:223], v[40:55]
    ds_read_b64_tr_b16 v[252:253], v3 offset:16992
    ds_read_b64_tr_b16 v[254:255], v3 offset:25440
    v_mbcnt_lo_u32_b32 v229, -1, 0
    v_mbcnt_hi_u32_b32 v229, -1, v229
    v_mfma_f32_32x32x16_bf16 v[56:71], v[232:235], v[220:223], v[56:71]
    s_sub_u32 s51, 0, s39
    s_max_i32 s51, s51, 0
    s_add_u32 s52, s51, s45
    s_add_u32 s51, s51, s44
    s_waitcnt lgkmcnt(4)
    v_mfma_f32_32x32x16_bf16 v[72:87], v[240:243], v[220:223], v[72:87]
    v_lshl_add_u32 v224, v229, 4, s52
    v_lshl_add_u32 v225, v229, 4, s51
    v_lshlrev_b32 v226, 4, v229
    v_add_u32 v226, 139264, v226
    s_waitcnt lgkmcnt(0)
    s_barrier
    s_branch L_e
L_rare_yc1:
    v_mov_b32 v224, v6
    s_nop 1
    v_permlane32_swap_b32 v224, v6
    v_max3_f32 v6, v6, v224, 0
    v_exp_f32 v7, -v6
    v_add_f32 v4, v4, v6
    v_mul_f32 v5, v5, v7
    s_branch L_ret_yc1
L_rare_yc:
    v_mov_b32 v224, v6
    s_nop 1
    v_permlane32_swap_b32 v224, v6
    v_max3_f32 v6, v6, v224, 0
    v_exp_f32 v7, -v6
    v_add_f32 v4, v4, v6
    v_mul_f32 v5, v5, v7
    s_branch L_ret_yc
L_rare_xc:
    s_nop 12
    v_mul_f32 v8, v8, v7
    v_mul_f32 v9, v9, v7
    v_mul_f32 v10, v10, v7
    v_mul_f32 v11, v11, v7
    v_mul_f32 v12, v12, v7
    v_mul_f32 v13, v13, v7
    v_mul_f32 v14, v14, v7
    v_mul_f32 v15, v15, v7
    v_mul_f32 v16, v16, v7
    v_mul_f32 v17, v17, v7
    v_mul_f32 v18, v18, v7
    v_mul_f32 v19, v19, v7
    v_mul_f32 v20, v20, v7
    v_mul_f32 v21, v21, v7
    v_mul_f32 v22, v22, v7
    v_mul_f32 v23, v23, v7
    v_mul_f32 v24, v24, v7
    v_mul_f32 v25, v25, v7
    v_mul_f32 v26, v26, v7
    v_mul_f32 v27, v27, v7
    v_mul_f32 v28, v28, v7
    v_mul_f32 v29, v29, v7
    v_mul_f32 v30, v30, v7
    v_mul_f32 v31, v31, v7
    v_mul_f32 v32, v32, v7
    v_mul_f32 v33, v33, v7
    v_mul_f32 v34, v34, v7
    v_mul_f32 v35, v35, v7
    v_mul_f32 v36, v36, v7
    v_mul_f32 v37, v37, v7
    v_mul_f32 v38, v38, v7
    v_mul_f32 v39, v39, v7
    v_mul_f32 v40, v40, v7
    v_mul_f32 v41, v41, v7
    v_mul_f32 v42, v42, v7
    v_mul_f32 v43, v43, v7
    v_mul_f32 v44, v44, v7
    v_mul_f32 v45, v45, v7
    v_mul_f32 v46, v46, v7
    v_mul_f32 v47, v47, v7
    v_mul_f32 v48, v48, v7
    v_mul_f32 v49, v49, v7
    v_mul_f32 v50, v50, v7
    v_mul_f32 v51, v51, v7
    v_mul_f32 v52, v52, v7
    v_mul_f32 v53, v53, v7
    v_mul_f32 v54, v54, v7
    v_mul_f32 v55, v55, v7
    v_mul_f32 v56, v56, v7
    v_mul_f32 v57, v57, v7
    v_mul_f32 v58, v58, v7
    v_mul_f32 v59, v59, v7
    v_mul_f32 v60, v60, v7
    v_mul_f32 v61, v61, v7
    v_mul_f32 v62, v62, v7
    v_mul_f32 v63, v63, v7
    v_mul_f32 v64, v64, v7
    v_mul_f32 v65, v65, v7
    v_mul_f32 v66, v66, v7
    v_mul_f32 v67, v67, v7
    v_mul_f32 v68, v68, v7
    v_mul_f32 v69, v69, v7
    v_mul_f32 v70, v70, v7
    v_mul_f32 v71, v71, v7
    v_mul_f32 v72, v72, v7
    v_mul_f32 v73, v73, v7
    v_mul_f32 v74, v74, v7
    v_mul_f32 v75, v75, v7
    v_mul_f32 v76, v76, v7
    v_mul_f32 v77, v77, v7
    v_mul_f32 v78, v78, v7
    v_mul_f32 v79, v79, v7
    v_mul_f32 v80, v80, v7
    v_mul_f32 v81, v81, v7
    v_mul_f32 v82, v82, v7
    v_mul_f32 v83, v83, v7
    v_mul_f32 v84, v84, v7
    v_mul_f32 v85, v85, v7
    v_mul_f32 v86, v86, v7
    v_mul_f32 v87, v87, v7
    v_mul_f32 v88, v88, v7
    v_mul_f32 v89, v89, v7
    v_mul_f32 v90, v90, v7
    v_mul_f32 v91, v91, v7
    v_mul_f32 v92, v92, v7
    v_mul_f32 v93, v93, v7
    v_mul_f32 v94, v94, v7
    v_mul_f32 v95, v95, v7
    v_mul_f32 v96, v96, v7
    v_mul_f32 v97, v97, v7
    v_mul_f32 v98, v98, v7
    v_mul_f32 v99, v99, v7
    v_mul_f32 v100, v100, v7
    v_mul_f32 v101, v101, v7
    v_mul_f32 v102, v102, v7
    v_mul_f32 v103, v103, v7
    v_mul_f32 v104, v104, v7
    v_mul_f32 v105, v105, v7
    v_mul_f32 v106, v106, v7
    v_mul_f32 v107, v107, v7
    v_mul_f32 v108, v108, v7
    v_mul_f32 v109, v109, v7
    v_mul_f32 v110, v110, v7
    v_mul_f32 v111, v111, v7
    v_mul_f32 v112, v112, v7
    v_mul_f32 v113, v113, v7
    v_mul_f32 v114, v114, v7
    v_mul_f32 v115, v115, v7
    v_mul_f32 v116, v116, v7
    v_mul_f32 v117, v117, v7
    v_mul_f32 v118, v118, v7
    v_mul_f32 v119, v119, v7
    v_mul_f32 v120, v120, v7
    v_mul_f32 v121, v121, v7
    v_mul_f32 v122, v122, v7
    v_mul_f32 v123, v123, v7
    v_mul_f32 v124, v124, v7
    v_mul_f32 v125, v125, v7
    v_mul_f32 v126, v126, v7
    v_mul_f32 v127, v127, v7
    v_mul_f32 v128, v128, v7
    v_mul_f32 v129, v129, v7
    v_mul_f32 v130, v130, v7
    v_mul_f32 v131, v131, v7
    v_mul_f32 v132, v132, v7
    v_mul_f32 v133, v133, v7
    v_mul_f32 v134, v134, v7
    v_mul_f32 v135, v135, v7
    s_branch L_ret_xc
L_rare_xd:
    s_nop 12
    v_mul_f32 v8, v8, v7
    v_mul_f32 v9, v9, v7
    v_mul_f32 v10, v10, v7
    v_mul_f32 v11, v11, v7
    v_mul_f32 v12, v12, v7
    v_mul_f32 v13, v13, v7
    v_mul_f32 v14, v14, v7
    v_mul_f32 v15, v15, v7
    v_mul_f32 v16, v16, v7
    v_mul_f32 v17, v17, v7
    v_mul_f32 v18, v18, v7
    v_mul_f32 v19, v19, v7
    v_mul_f32 v20, v20, v7
    v_mul_f32 v21, v21, v7
    v_mul_f32 v22, v22, v7
    v_mul_f32 v23, v23, v7
    v_mul_f32 v24, v24, v7
    v_mul_f32 v25, v25, v7
    v_mul_f32 v26, v26, v7
    v_mul_f32 v27, v27, v7
    v_mul_f32 v28, v28, v7
    v_mul_f32 v29, v29, v7
    v_mul_f32 v30, v30, v7
    v_mul_f32 v31, v31, v7
    v_mul_f32 v32, v32, v7
    v_mul_f32 v33, v33, v7
    v_mul_f32 v34, v34, v7
    v_mul_f32 v35, v35, v7
    v_mul_f32 v36, v36, v7
    v_mul_f32 v37, v37, v7
    v_mul_f32 v38, v38, v7
    v_mul_f32 v39, v39, v7
    v_mul_f32 v40, v40, v7
    v_mul_f32 v41, v41, v7
    v_mul_f32 v42, v42, v7
    v_mul_f32 v43, v43, v7
    v_mul_f32 v44, v44, v7
    v_mul_f32 v45, v45, v7
    v_mul_f32 v46, v46, v7
    v_mul_f32 v47, v47, v7
    v_mul_f32 v48, v48, v7
    v_mul_f32 v49, v49, v7
    v_mul_f32 v50, v50, v7
    v_mul_f32 v51, v51, v7
    v_mul_f32 v52, v52, v7
    v_mul_f32 v53, v53, v7
    v_mul_f32 v54, v54, v7
    v_mul_f32 v55, v55, v7
    v_mul_f32 v56, v56, v7
    v_mul_f32 v57, v57, v7
    v_mul_f32 v58, v58, v7
    v_mul_f32 v59, v59, v7
    v_mul_f32 v60, v60, v7
    v_mul_f32 v61, v61, v7
    v_mul_f32 v62, v62, v7
    v_mul_f32 v63, v63, v7
    v_mul_f32 v64, v64, v7
    v_mul_f32 v65, v65, v7
    v_mul_f32 v66, v66, v7
    v_mul_f32 v67, v67, v7
    v_mul_f32 v68, v68, v7
    v_mul_f32 v69, v69, v7
    v_mul_f32 v70, v70, v7
    v_mul_f32 v71, v71, v7
    v_mul_f32 v72, v72, v7
    v_mul_f32 v73, v73, v7
    v_mul_f32 v74, v74, v7
    v_mul_f32 v75, v75, v7
    v_mul_f32 v76, v76, v7
    v_mul_f32 v77, v77, v7
    v_mul_f32 v78, v78, v7
    v_mul_f32 v79, v79, v7
    v_mul_f32 v80, v80, v7
    v_mul_f32 v81, v81, v7
    v_mul_f32 v82, v82, v7
    v_mul_f32 v83, v83, v7
    v_mul_f32 v84, v84, v7
    v_mul_f32 v85, v85, v7
    v_mul_f32 v86, v86, v7
    v_mul_f32 v87, v87, v7
    v_mul_f32 v88, v88, v7
    v_mul_f32 v89, v89, v7
    v_mul_f32 v90, v90, v7
    v_mul_f32 v91, v91, v7
    v_mul_f32 v92, v92, v7
    v_mul_f32 v93, v93, v7
    v_mul_f32 v94, v94, v7
    v_mul_f32 v95, v95, v7
    v_mul_f32 v96, v96, v7
    v_mul_f32 v97, v97, v7
    v_mul_f32 v98, v98, v7
    v_mul_f32 v99, v99, v7
    v_mul_f32 v100, v100, v7
    v_mul_f32 v101, v101, v7
    v_mul_f32 v102, v102, v7
    v_mul_f32 v103, v103, v7
    v_mul_f32 v104, v104, v7
    v_mul_f32 v105, v105, v7
    v_mul_f32 v106, v106, v7
    v_mul_f32 v107, v107, v7
    v_mul_f32 v108, v108, v7
    v_mul_f32 v109, v109, v7
    v_mul_f32 v110, v110, v7
    v_mul_f32 v111, v111, v7
    v_mul_f32 v112, v112, v7
    v_mul_f32 v113, v113, v7
    v_mul_f32 v114, v114, v7
    v_mul_f32 v115, v115, v7
    v_mul_f32 v116, v116, v7
    v_mul_f32 v117, v117, v7
    v_mul_f32 v118, v118, v7
    v_mul_f32 v119, v119, v7
    v_mul_f32 v120, v120, v7
    v_mul_f32 v121, v121, v7
    v_mul_f32 v122, v122, v7
    v_mul_f32 v123, v123, v7
    v_mul_f32 v124, v124, v7
    v_mul_f32 v125, v125, v7
    v_mul_f32 v126, v126, v7
    v_mul_f32 v127, v127, v7
    v_mul_f32 v128, v128, v7
    v_mul_f32 v129, v129, v7
    v_mul_f32 v130, v130, v7
    v_mul_f32 v131, v131, v7
    v_mul_f32 v132, v132, v7
    v_mul_f32 v133, v133, v7
    v_mul_f32 v134, v134, v7
    v_mul_f32 v135, v135, v7
    s_branch L_ret_xd
L_rare_xe:
    s_nop 12
    v_mul_f32 v8, v8, v227
    v_mul_f32 v9, v9, v227
    v_mul_f32 v10, v10, v227
    v_mul_f32 v11, v11, v227
    v_mul_f32 v12, v12, v227
    v_mul_f32 v13, v13, v227
    v_mul_f32 v14, v14, v227
    v_mul_f32 v15, v15, v227
    v_mul_f32 v16, v16, v227
    v_mul_f32 v17, v17, v227
    v_mul_f32 v18, v18, v227
    v_mul_f32 v19, v19, v227
    v_mul_f32 v20, v20, v227
    v_mul_f32 v21, v21, v227
    v_mul_f32 v22, v22, v227
    v_mul_f32 v23, v23, v227
    v_mul_f32 v24, v24, v227
    v_mul_f32 v25, v25, v227
    v_mul_f32 v26, v26, v227
    v_mul_f32 v27, v27, v227
    v_mul_f32 v28, v28, v227
    v_mul_f32 v29, v29, v227
    v_mul_f32 v30, v30, v227
    v_mul_f32 v31, v31, v227
    v_mul_f32 v32, v32, v227
    v_mul_f32 v33, v33, v227
    v_mul_f32 v34, v34, v227
    v_mul_f32 v35, v35, v227
    v_mul_f32 v36, v36, v227
    v_mul_f32 v37, v37, v227
    v_mul_f32 v38, v38, v227
    v_mul_f32 v39, v39, v227
    v_mul_f32 v40, v40, v227
    v_mul_f32 v41, v41, v227
    v_mul_f32 v42, v42, v227
    v_mul_f32 v43, v43, v227
    v_mul_f32 v44, v44, v227
    v_mul_f32 v45, v45, v227
    v_mul_f32 v46, v46, v227
    v_mul_f32 v47, v47, v227
    v_mul_f32 v48, v48, v227
    v_mul_f32 v49, v49, v227
    v_mul_f32 v50, v50, v227
    v_mul_f32 v51, v51, v227
    v_mul_f32 v52, v52, v227
    v_mul_f32 v53, v53, v227
    v_mul_f32 v54, v54, v227
    v_mul_f32 v55, v55, v227
    v_mul_f32 v56, v56, v227
    v_mul_f32 v57, v57, v227
    v_mul_f32 v58, v58, v227
    v_mul_f32 v59, v59, v227
    v_mul_f32 v60, v60, v227
    v_mul_f32 v61, v61, v227
    v_mul_f32 v62, v62, v227
    v_mul_f32 v63, v63, v227
    v_mul_f32 v64, v64, v227
    v_mul_f32 v65, v65, v227
    v_mul_f32 v66, v66, v227
    v_mul_f32 v67, v67, v227
    v_mul_f32 v68, v68, v227
    v_mul_f32 v69, v69, v227
    v_mul_f32 v70, v70, v227
    v_mul_f32 v71, v71, v227
    v_mul_f32 v72, v72, v227
    v_mul_f32 v73, v73, v227
    v_mul_f32 v74, v74, v227
    v_mul_f32 v75, v75, v227
    v_mul_f32 v76, v76, v227
    v_mul_f32 v77, v77, v227
    v_mul_f32 v78, v78, v227
    v_mul_f32 v79, v79, v227
    v_mul_f32 v80, v80, v227
    v_mul_f32 v81, v81, v227
    v_mul_f32 v82, v82, v227
    v_mul_f32 v83, v83, v227
    v_mul_f32 v84, v84, v227
    v_mul_f32 v85, v85, v227
    v_mul_f32 v86, v86, v227
    v_mul_f32 v87, v87, v227
    v_mul_f32 v88, v88, v227
    v_mul_f32 v89, v89, v227
    v_mul_f32 v90, v90, v227
    v_mul_f32 v91, v91, v227
    v_mul_f32 v92, v92, v227
    v_mul_f32 v93, v93, v227
    v_mul_f32 v94, v94, v227
    v_mul_f32 v95, v95, v227
    v_mul_f32 v96, v96, v227
    v_mul_f32 v97, v97, v227
    v_mul_f32 v98, v98, v227
    v_mul_f32 v99, v99, v227
    v_mul_f32 v100, v100, v227
    v_mul_f32 v101, v101, v227
    v_mul_f32 v102, v102, v227
    v_mul_f32 v103, v103, v227
    v_mul_f32 v104, v104, v227
    v_mul_f32 v105, v105, v227
    v_mul_f32 v106, v106, v227
    v_mul_f32 v107, v107, v227
    v_mul_f32 v108, v108, v227
    v_mul_f32 v109, v109, v227
    v_mul_f32 v110, v110, v227
    v_mul_f32 v111, v111, v227
    v_mul_f32 v112, v112, v227
    v_mul_f32 v113, v113, v227
    v_mul_f32 v114, v114, v227
    v_mul_f32 v115, v115, v227
    v_mul_f32 v116, v116, v227
    v_mul_f32 v117, v117, v227
    v_mul_f32 v118, v118, v227
    v_mul_f32 v119, v119, v227
    v_mul_f32 v120, v120, v227
    v_mul_f32 v121, v121, v227
    v_mul_f32 v122, v122, v227
    v_mul_f32 v123, v123, v227
    v_mul_f32 v124, v124, v227
    v_mul_f32 v125, v125, v227
    v_mul_f32 v126, v126, v227
    v_mul_f32 v127, v127, v227
    v_mul_f32 v128, v128, v227
    v_mul_f32 v129, v129, v227
    v_mul_f32 v130, v130, v227
    v_mul_f32 v131, v131, v227
    v_mul_f32 v132, v132, v227
    v_mul_f32 v133, v133, v227
    v_mul_f32 v134, v134, v227
    v_mul_f32 v135, v135, v227
    s_branch L_ret_xe
L_rare_xf:
    s_nop 12
    v_mul_f32 v8, v8, v227
    v_mul_f32 v9, v9, v227
    v_mul_f32 v10, v10, v227
    v_mul_f32 v11, v11, v227
    v_mul_f32 v12, v12, v227
    v_mul_f32 v13, v13, v227
    v_mul_f32 v14, v14, v227
    v_mul_f32 v15, v15, v227
    v_mul_f32 v16, v16, v227
    v_mul_f32 v17, v17, v227
    v_mul_f32 v18, v18, v227
    v_mul_f32 v19, v19, v227
    v_mul_f32 v20, v20, v227
    v_mul_f32 v21, v21, v227
    v_mul_f32 v22, v22, v227
    v_mul_f32 v23, v23, v227
    v_mul_f32 v24, v24, v227
    v_mul_f32 v25, v25, v227
    v_mul_f32 v26, v26, v227
    v_mul_f32 v27, v27, v227
    v_mul_f32 v28, v28, v227
    v_mul_f32 v29, v29, v227
    v_mul_f32 v30, v30, v227
    v_mul_f32 v31, v31, v227
    v_mul_f32 v32, v32, v227
    v_mul_f32 v33, v33, v227
    v_mul_f32 v34, v34, v227
    v_mul_f32 v35, v35, v227
    v_mul_f32 v36, v36, v227
    v_mul_f32 v37, v37, v227
    v_mul_f32 v38, v38, v227
    v_mul_f32 v39, v39, v227
    v_mul_f32 v40, v40, v227
    v_mul_f32 v41, v41, v227
    v_mul_f32 v42, v42, v227
    v_mul_f32 v43, v43, v227
    v_mul_f32 v44, v44, v227
    v_mul_f32 v45, v45, v227
    v_mul_f32 v46, v46, v227
    v_mul_f32 v47, v47, v227
    v_mul_f32 v48, v48, v227
    v_mul_f32 v49, v49, v227
    v_mul_f32 v50, v50, v227
    v_mul_f32 v51, v51, v227
    v_mul_f32 v52, v52, v227
    v_mul_f32 v53, v53, v227
    v_mul_f32 v54, v54, v227
    v_mul_f32 v55, v55, v227
    v_mul_f32 v56, v56, v227
    v_mul_f32 v57, v57, v227
    v_mul_f32 v58, v58, v227
    v_mul_f32 v59, v59, v227
    v_mul_f32 v60, v60, v227
    v_mul_f32 v61, v61, v227
    v_mul_f32 v62, v62, v227
    v_mul_f32 v63, v63, v227
    v_mul_f32 v64, v64, v227
    v_mul_f32 v65, v65, v227
    v_mul_f32 v66, v66, v227
    v_mul_f32 v67, v67, v227
    v_mul_f32 v68, v68, v227
    v_mul_f32 v69, v69, v227
    v_mul_f32 v70, v70, v227
    v_mul_f32 v71, v71, v227
    v_mul_f32 v72, v72, v227
    v_mul_f32 v73, v73, v227
    v_mul_f32 v74, v74, v227
    v_mul_f32 v75, v75, v227
    v_mul_f32 v76, v76, v227
    v_mul_f32 v77, v77, v227
    v_mul_f32 v78, v78, v227
    v_mul_f32 v79, v79, v227
    v_mul_f32 v80, v80, v227
    v_mul_f32 v81, v81, v227
    v_mul_f32 v82, v82, v227
    v_mul_f32 v83, v83, v227
    v_mul_f32 v84, v84, v227
    v_mul_f32 v85, v85, v227
    v_mul_f32 v86, v86, v227
    v_mul_f32 v87, v87, v227
    v_mul_f32 v88, v88, v227
    v_mul_f32 v89, v89, v227
    v_mul_f32 v90, v90, v227
    v_mul_f32 v91, v91, v227
    v_mul_f32 v92, v92, v227
    v_mul_f32 v93, v93, v227
    v_mul_f32 v94, v94, v227
    v_mul_f32 v95, v95, v227
    v_mul_f32 v96, v96, v227
    v_mul_f32 v97, v97, v227
    v_mul_f32 v98, v98, v227
    v_mul_f32 v99, v99, v227
    v_mul_f32 v100, v100, v227
    v_mul_f32 v101, v101, v227
    v_mul_f32 v102, v102, v227
    v_mul_f32 v103, v103, v227
    v_mul_f32 v104, v104, v227
    v_mul_f32 v105, v105, v227
    v_mul_f32 v106, v106, v227
    v_mul_f32 v107, v107, v227
    v_mul_f32 v108, v108, v227
    v_mul_f32 v109, v109, v227
    v_mul_f32 v110, v110, v227
    v_mul_f32 v111, v111, v227
    v_mul_f32 v112, v112, v227
    v_mul_f32 v113, v113, v227
    v_mul_f32 v114, v114, v227
    v_mul_f32 v115, v115, v227
    v_mul_f32 v116, v116, v227
    v_mul_f32 v117, v117, v227
    v_mul_f32 v118, v118, v227
    v_mul_f32 v119, v119, v227
    v_mul_f32 v120, v120, v227
    v_mul_f32 v121, v121, v227
    v_mul_f32 v122, v122, v227
    v_mul_f32 v123, v123, v227
    v_mul_f32 v124, v124, v227
    v_mul_f32 v125, v125, v227
    v_mul_f32 v126, v126, v227
    v_mul_f32 v127, v127, v227
    v_mul_f32 v128, v128, v227
    v_mul_f32 v129, v129, v227
    v_mul_f32 v130, v130, v227
    v_mul_f32 v131, v131, v227
    v_mul_f32 v132, v132, v227
    v_mul_f32 v133, v133, v227
    v_mul_f32 v134, v134, v227
    v_mul_f32 v135, v135, v227
    s_branch L_ret_xf
L_loader:
    s_setprio 0
    s_ff1_i32_b32 s51, s27
    s_bitset0_b32 s27, s51
    s_mov_b32 s47, s37
    s_mov_b32 s41, 0
    s_add_u32 s50, s28, s33
    s_add_u32 s50, s50, 2
    s_mov_b32 s48, 0
    s_cmp_gt_u32 s33, 1
    s_subb_u32 s50, s50, 0
    s_mov_b32 s38, 33280
    s_mov_b32 s39, -33792
    s_mov_b32 s45, s54
    s_waitcnt vmcnt(8)
    s_barrier
    s_branch L_ly
    s_endpgm
    s_endpgm
    s_endpgm
    s_endpgm
    s_endpgm
    s_endpgm
    s_endpgm
    s_endpgm
    s_endpgm
    s_endpgm
    s_endpgm
    s_endpgm
    s_endpgm
L_lx:
    s_mov_b32 s49, 0
    s_cmp_eq_u32 s46, -1
    s_cselect_b32 s46, s47, s46
    s_cselect_b32 s47, -2, s47
    s_cmp_eq_u32 s46, -2
    s_cselect_b32 s48, 2, s48
    s_cmp_lt_i32 s46, 0
    s_cbranch_scc1 L_nov
    s_mov_b32 s49, 1
    s_add_u32 s52, s46, 4096
    s_add_u32 m0, s45, 0
    s_nop 0
    buffer_load_dwordx4 v1, s[12:15], s46 offen offset:0 lds
    s_add_u32 m0, s45, 32
    s_nop 0
    buffer_load_dwordx4 v1, s[12:15], s46 offen offset:1024 lds
    s_add_u32 m0, s45, 64
    s_nop 0
    buffer_load_dwordx4 v1, s[12:15], s46 offen offset:2048 lds
    s_add_u32 m0, s45, 96
    s_nop 0
    buffer_load_dwordx4 v1, s[12:15], s46 offen offset:3072 lds
    s_add_u32 m0, s45, 4224
    s_nop 0
    buffer_load_dwordx4 v1, s[12:15], s52 offen offset:0 lds
    s_add_u32 m0, s45, 4256
    s_nop 0
    buffer_load_dwordx4 v1, s[12:15], s52 offen offset:1024 lds
    s_add_u32 m0, s45, 4288
    s_nop 0
    buffer_load_dwordx4 v1, s[12:15], s52 offen offset:2048 lds
    s_add_u32 m0, s45, 4320
    s_nop 0
    buffer_load_dwordx4 v1, s[12:15], s52 offen offset:3072 lds
    s_add_u32 s45, s45, s39
    s_sub_u32 s39, 0, s39
L_nov:
    s_add_u32 s52, s48, s49
    s_mov_b32 s48, s49
    s_cmp_eq_u32 s52, 2
    s_cbranch_scc1 L_w2_x
    s_cmp_eq_u32 s52, 1
    s_cbranch_scc1 L_w1_x
    s_waitcnt vmcnt(0)
L_w1_x:
    s_waitcnt vmcnt(8)
L_w2_x:
    s_waitcnt vmcnt(16)
    s_barrier
L_ly:
    s_mov_b32 s46, s47
    s_mov_b32 s47, -1
    s_mov_b32 s49, 1
    s_cmp_eq_u32 s27, 0
    s_cbranch_scc1 L_nok
    s_ff1_i32_b32 s51, s27
    s_bitset0_b32 s27, s51
    s_lshl_b32 s51, s51, 15
    s_add_u32 s47, s51, s26
    s_add_u32 s52, s47, 4096
    s_add_u32 m0, s44, 0
    s_nop 0
    buffer_load_dwordx4 v1, s[8:11], s47 offen offset:0 lds
    s_add_u32 m0, s44, 16
    s_nop 0
    buffer_load_dwordx4 v1, s[8:11], s47 offen offset:1024 lds
    s_add_u32 m0, s44, 32
    s_nop 0
    buffer_load_dwordx4 v1, s[8:11], s47 offen offset:2048 lds
    s_add_u32 m0, s44, 48
    s_nop 0
    buffer_load_dwordx4 v1, s[8:11], s47 offen offset:3072 lds
    s_add_u32 m0, s44, 4160
    s_nop 0
    buffer_load_dwordx4 v1, s[8:11], s52 offen offset:0 lds
    s_add_u32 m0, s44, 4176
    s_nop 0
    buffer_load_dwordx4 v1, s[8:11], s52 offen offset:1024 lds
    s_add_u32 m0, s44, 4192
    s_nop 0
    buffer_load_dwordx4 v1, s[8:11], s52 offen offset:2048 lds
    s_add_u32 m0, s44, 4208
    s_nop 0
    buffer_load_dwordx4 v1, s[8:11], s52 offen offset:3072 lds
    s_branch L_kdone
L_nok:
    s_mov_b32 s49, 0
    s_cmp_eq_u32 s41, 1
    s_cbranch_scc1 L_kdone
    s_mov_b32 s49, 1
    s_mov_b32 s41, 1
    s_mov_b32 s27, s32
    s_mov_b32 s25, s30
    s_mov_b32 s26, s31
    s_lshl_b32 s51, s25, 15
    s_add_u32 s51, s51, s26
    s_add_u32 s52, s51, 4096
    s_add_u32 m0, s44, 0
    s_nop 0
    buffer_load_dwordx4 v1, s[4:7], s51 offen offset:0 lds
    s_add_u32 m0, s44, 16
    s_nop 0
    buffer_load_dwordx4 v1, s[4:7], s51 offen offset:1024 lds
    s_add_u32 m0, s44, 32
    s_nop 0
    buffer_load_dwordx4 v1, s[4:7], s51 offen offset:2048 lds
    s_add_u32 m0, s44, 48
    s_nop 0
    buffer_load_dwordx4 v1, s[4:7], s51 offen offset:3072 lds
    s_add_u32 m0, s44, 4160
    s_nop 0
    buffer_load_dwordx4 v1, s[4:7], s52 offen offset:0 lds
    s_add_u32 m0, s44, 4176
    s_nop 0
    buffer_load_dwordx4 v1, s[4:7], s52 offen offset:1024 lds
    s_add_u32 m0, s44, 4192
    s_nop 0
    buffer_load_dwordx4 v1, s[4:7], s52 offen offset:2048 lds
    s_add_u32 m0, s44, 4208
    s_nop 0
    buffer_load_dwordx4 v1, s[4:7], s52 offen offset:3072 lds
L_kdone:
    s_add_u32 s44, s44, s38
    s_sub_u32 s38, 0, s38
    s_cmp_eq_u32 s50, 0
    s_cselect_b32 s48, 0, s48
    s_add_u32 s52, s48, s49
    s_mov_b32 s48, s49
    s_cmp_eq_u32 s52, 2
    s_cbranch_scc1 L_w2_y
    s_cmp_eq_u32 s52, 1
    s_cbranch_scc1 L_w1_y
    s_waitcnt vmcnt(0)
L_w1_y:
    s_waitcnt vmcnt(8)
L_w2_y:
    s_waitcnt vmcnt(16)
    s_barrier
    s_sub_u32 s50, s50, 1
    s_cbranch_scc0 L_lx
    s_waitcnt lgkmcnt(0)
    s_barrier
    s_endpgm
.section .rodata,"a"
.p2align 6
.amdhsa_kernel standalone__block_sparse_attn__prompt_kernel
  .amdhsa_next_free_vgpr 256
  .amdhsa_next_free_sgpr 96
  .amdhsa_accum_offset 256
  .amdhsa_group_segment_fixed_size 0
  .amdhsa_kernarg_size 56
  .amdhsa_user_sgpr_count 2
  .amdhsa_user_sgpr_kernarg_segment_ptr 1
  .amdhsa_system_sgpr_workgroup_id_x 1
.end_amdhsa_kernel
```
